```python
import torch

def _softmax(x, axis=-1):
    return torch.softmax(x, dim=axis)

def _gelu(x):
    return torch.nn.functional.gelu(x, approximate='tanh')

def _silu(x):
    return torch.nn.functional.silu(x)

def _sigmoid(x):
    return torch.sigmoid(x)

def _layernorm(x, axis=-1, eps=1e-05):
    m = x.mean(dim=axis, keepdim=True)
    v = x.var(dim=axis, keepdim=True, unbiased=False)
    return (x - m) / torch.sqrt(v + eps)

def _scatter_add(tgt, idx, src, axis=0):
    return tgt.clone().index_add_(axis, idx, src)

def _segment_sum(src, seg, n):
    out = torch.zeros((n,) + src.shape[1:], dtype=src.dtype)
    return out.index_add_(0, seg, src)

def _pad(x, pw):
    flat = tuple((v for pair in reversed(pw) for v in pair))
    return torch.nn.functional.pad(x, flat)
kernel_name = 'adaLN_cond__ssm_conv_s4d__glu_gated_swiglu__prompt'

def setup_inputs():

    _w = lambda a: (lambda t: t.to(torch.bfloat16) if t.is_floating_point() else t)(torch.as_tensor(a))

    def _A_setup():
        Bsz, L, D, N = (1, 2048, 448, 256)
        return {'u': _w((lambda *s: torch.randn(*s, dtype=torch.bfloat16) * 0.05)(Bsz, L, D)), 'log_A_real': _w((lambda *s: torch.randn(*s, dtype=torch.bfloat16) * 3.2)(D, N) * 0.5), 'A_imag': _w((lambda *s: torch.randn(*s, dtype=torch.bfloat16) * 0.05)(D, N) * 3.14), 'C_real': _w((lambda *s: torch.randn(*s, dtype=torch.bfloat16) * 0.2)(D, N) / N ** 0.5), 'C_imag': _w((lambda *s: torch.randn(*s, dtype=torch.bfloat16) * 0.2)(D, N) / N ** 0.5), 'log_dt': _w((lambda *s: torch.randn(*s, dtype=torch.bfloat16) * 0.05)(D) * 0.5 - 4.0), 'D_skip': _w((lambda *s: torch.randn(*s, dtype=torch.bfloat16) * 0.05)(D))}
    _A_in = _A_setup()

    def _B_setup():
        B, S, D, F = (1, 2048, 448, 1792)
        return {'x': _w((lambda *s: torch.randn(*s, dtype=torch.bfloat16) * 0.05)(B, S, D)), 'w1': _w((lambda *s: torch.randn(*s, dtype=torch.bfloat16) * 0.4)(D, F) * (2.0 / D) ** 0.5), 'w3': _w((lambda *s: torch.randn(*s, dtype=torch.bfloat16) * 0.4)(D, F) * (2.0 / D) ** 0.5), 'w2': _w((lambda *s: torch.randn(*s, dtype=torch.bfloat16) * 0.4)(F, D) * (2.0 / F) ** 0.5)}
    _B_in = _B_setup()
    return {'A_u': _A_in['u'], 'A_log_A_real': _A_in['log_A_real'], 'A_A_imag': _A_in['A_imag'], 'A_C_real': _A_in['C_real'], 'A_C_imag': _A_in['C_imag'], 'A_log_dt': _A_in['log_dt'], 'A_D_skip': _A_in['D_skip'], 'B_x': _B_in['x'], 'B_w1': _B_in['w1'], 'B_w3': _B_in['w3'], 'B_w2': _B_in['w2'], 'c': _w((lambda *s: torch.randn(*s, dtype=torch.bfloat16) * 0.4)(1, 448) * 8.0), 'w_mod': _w((lambda *s: torch.randn(*s, dtype=torch.bfloat16) * 0.4)(448, 6 * 448) * 448 ** (-0.5) * 8.0)}

def reference(A_u, A_log_A_real, A_A_imag, A_C_real, A_C_imag, A_log_dt, A_D_skip, B_x, B_w1, B_w3, B_w2, c, w_mod):

    def _A_ref(u, log_A_real, A_imag, C_real, C_imag, log_dt, D_skip):
        L = u.shape[1]
        dt = torch.exp(log_dt)
        A = -torch.exp(log_A_real) + 1j * A_imag
        C = (C_real + 1j * C_imag) * dt[:, None]
        pos = (lambda x, dt: x.to(dt))(torch.arange(L), log_dt.dtype)
        P = torch.exp((A * dt[:, None])[:, :, None] * pos[None, None, :])
        K = 2.0 * torch.einsum('dn,dnl->dl', C, P).real
        L2 = 2 * L
        u_t = (lambda x, *d: x.permute(*d))(u, 0, 2, 1)
        Kf = (lambda x, *a, **k: torch.fft.rfft(x.float(), *a, **k))(K, L2)
        Uf = (lambda x, *a, **k: torch.fft.rfft(x.float(), *a, **k))(u_t, L2)
        y = (lambda x, *a, **k: torch.fft.irfft(x, *a, **k).to(torch.bfloat16))(Uf * Kf[None, :, :], L2)[:, :, :L]
        y = (lambda x, *d: x.permute(*d))(y, 0, 2, 1)
        return y + u * D_skip[None, None, :]

    def _B_ref(x, w1, w3, w2):
        gate = torch.einsum('bsd,df->bsf', x, w1)
        up = torch.einsum('bsd,df->bsf', x, w3)
        h = _silu(gate) * up
        out = torch.einsum('bsf,fd->bsd', h, w2)
        return out
    x = A_u
    mod = (_silu(c) @ w_mod).reshape(c.shape[0], 6, 1, -1)
    sa, ca, ga, sb, cb, gb = (mod[:, 0].clone(), mod[:, 1].clone(), mod[:, 2].clone(), mod[:, 3].clone(), mod[:, 4].clone(), mod[:, 5].clone())
    h = _layernorm(x, axis=-1) * (1 + ca) + sa
    x = x + ga * _A_ref(h, A_log_A_real, A_A_imag, A_C_real, A_C_imag, A_log_dt, A_D_skip)
    h = _layernorm(x, axis=-1) * (1 + cb) + sb
    x = x + gb * _B_ref(h, B_w1, B_w3, B_w2)
    return x
```

```asm
; @launch kernel=k12_kernel grid=(716,1,1) block=(256,1,1) lds=46080
; @launch kernel=k34_kernel grid=(256,1,1) block=(512,1,1) lds=132352
.amdgcn_target "amdgcn-amd-amdhsa--gfx950"
.text
.globl k12_kernel
.p2align 8
.type k12_kernel,@function
k12_kernel:
    s_cmp_ge_u32 s2, 716
    s_cbranch_scc1 k12_kernel_exit
    s_load_dwordx16 s[16:31], s[0:1], 0
    s_load_dwordx16 s[32:47], s[0:1], 64
    v_and_b32 v1, 63, v0
    v_lshrrev_b32 v2, 6, v0
    s_nop 0
    v_readfirstlane_b32 s4, v2
    s_waitcnt lgkmcnt(0)
    s_cmp_lt_u32 s2, 84
    s_nop 2
    s_cbranch_scc1 k12_mod
    s_cmp_lt_u32 s2, 148
    s_cbranch_scc1 k12_st
    s_cmp_lt_u32 s2, 212
    s_cbranch_scc1 k12_ln
    s_cmp_lt_u32 s2, 268
    s_cbranch_scc1 k12_w2
k12_chan:
    s_sub_u32 s5, s2, 268
    s_mov_b32 s48, s18
    s_mov_b32 s49, s19
    s_mov_b32 s50, 0x38000
    s_mov_b32 s51, 0x20000
    s_mov_b32 s52, s20
    s_mov_b32 s53, s21
    s_mov_b32 s54, 0x38000
    s_mov_b32 s55, 0x20000
    s_mov_b32 s56, s22
    s_mov_b32 s57, s23
    s_mov_b32 s58, 0x38000
    s_mov_b32 s59, 0x20000
    s_mov_b32 s60, s24
    s_mov_b32 s61, s25
    s_mov_b32 s62, 0x38000
    s_mov_b32 s63, 0x20000
    s_mov_b32 s64, s26
    s_mov_b32 s65, s27
    s_mov_b32 s66, 0x380
    s_mov_b32 s67, 0x20000
    s_mov_b32 s68, s28
    s_mov_b32 s69, s29
    s_mov_b32 s70, 0x380
    s_mov_b32 s71, 0x20000
    s_mov_b32 s72, s44
    s_mov_b32 s73, s45
    s_mov_b32 s74, 0x100
    s_mov_b32 s75, 0x20000
    s_lshl_b32 s6, s5, 9
    s_lshl_b32 s7, s5, 1
    v_lshlrev_b32 v3, 1, v0
    buffer_load_ushort v4, v3, s[48:51], s6 offen
    buffer_load_ushort v5, v3, s[52:55], s6 offen
    buffer_load_ushort v6, v3, s[56:59], s6 offen
    buffer_load_ushort v7, v3, s[60:63], s6 offen
    buffer_load_ushort v8, off, s[64:67], s7
    buffer_load_ushort v160, off, s[68:71], s7
    v_lshlrev_b32 v9, 4, v0
    v_and_b32 v16, 15, v1
    v_lshrrev_b32 v17, 4, v1
    v_and_b32 v18, 1, v17
    v_lshrrev_b32 v19, 1, v17
    v_lshlrev_b32 v28, 3, v16
    v_lshl_add_u32 v28, v18, 2, v28
    v_lshl_add_u32 v28, v19, 7, v28
    v_sub_u32 v28, 284, v28
    v_lshlrev_b32 v28, 1, v28
    v_lshlrev_b32 v18, 5, v17
    v_lshl_add_u32 v19, v16, 1, v18
    v_sub_u32 v19, 415, v19
    v_add_u32 v21, v16, v18
    v_sub_u32 v21, 735, v21
    v_cmp_gt_u32 vcc, 2, v17
    s_nop 1
    v_cndmask_b32 v29, v21, v19, vcc
    v_mov_b32 v19, 16
    v_cndmask_b32 v30, v19, 1, vcc
    v_sub_u32 v30, v29, v30
    v_lshlrev_b32 v29, 1, v29
    v_lshlrev_b32 v30, 1, v30
    v_and_b32 v19, 1, v16
    v_lshlrev_b32 v19, 7, v19
    v_lshrrev_b32 v21, 1, v16
    v_add_u32 v21, v21, v18
    v_sub_u32 v31, v19, v21
    v_add_u32 v31, 903, v31
    v_lshlrev_b32 v31, 1, v31
    s_mul_i32 s8, s4, 8704
    v_lshlrev_b32 v32, 2, v1
    v_add_u32 v32, s8, v32
    v_mul_u32_u24 v33, 272, v16
    v_lshl_add_u32 v33, v17, 4, v33
    v_add_u32 v33, s8, v33
    v_mov_b32 v12, 0
    v_mov_b32 v13, 0
    v_mov_b32 v14, 0
    v_mov_b32 v15, 0
    v_add_u32 v10, 35072, v9
    ds_write_b128 v10, v[12:15]
    ds_write_b128 v10, v[12:15] offset:4096
    v_min_u32 v11, 39, v1
    v_lshlrev_b32 v11, 4, v11
    v_add_u32 v11, 43264, v11
    ds_write_b128 v11, v[12:15]
    s_waitcnt vmcnt(0)
    v_lshlrev_b32 v4, 16, v4
    v_lshlrev_b32 v5, 16, v5
    v_lshlrev_b32 v6, 16, v6
    v_lshlrev_b32 v7, 16, v7
    v_lshlrev_b32 v8, 16, v8
    v_mul_f32 v8, 0x3fb8aa3b, v8
    v_mul_f32 v4, 0x3fb8aa3b, v4
    v_exp_f32 v8, v8
    v_exp_f32 v4, v4
    v_cvt_pk_bf16_f32 v8, v8, v8
    v_lshlrev_b32 v8, 16, v8
    v_cvt_pk_bf16_f32 v4, v4, v4
    v_lshlrev_b32 v4, 16, v4
    v_mul_f32 v12, v4, v8
    v_mul_f32 v12, 0xbfb8aa3b, v12
    v_mul_f32 v13, v5, v8
    v_mul_f32 v13, 0x3e22f983, v13
    v_mul_f32 v14, v6, v8
    v_add_f32 v14, v14, v14
    v_mul_f32 v15, v7, v8
    v_add_f32 v15, v15, v15
    v_mul_f32 v36, 0x3f800000, v12
    v_mul_f32 v37, 0x3f800000, v13
    v_fract_f32 v37, v37
    v_exp_f32 v34, v36
    v_cos_f32 v36, v37
    v_sin_f32 v37, v37
    v_mul_f32 v36, v36, v34
    v_mul_f32 v37, v37, v34
    v_mul_f32 v38, 0x41000000, v12
    v_mul_f32 v39, 0x41000000, v13
    v_fract_f32 v39, v39
    v_exp_f32 v34, v38
    v_cos_f32 v38, v39
    v_sin_f32 v39, v39
    v_mul_f32 v38, v38, v34
    v_mul_f32 v39, v39, v34
    v_mul_f32 v40, 0x43000000, v12
    v_mul_f32 v41, 0x43000000, v13
    v_fract_f32 v41, v41
    v_exp_f32 v34, v40
    v_cos_f32 v40, v41
    v_sin_f32 v41, v41
    v_mul_f32 v40, v40, v34
    v_mul_f32 v41, v41, v34
    v_cvt_pk_bf16_f32 v20, v14, -v15
    ds_write_b32 v32, v20 offset:0
    v_mov_b32 v24, 0x00003f80
    ds_write_b32 v32, v24 offset:4352
    v_cvt_pk_bf16_f32 v21, v36, v37
    ds_write_b32 v32, v21 offset:4624
    v_cvt_pk_bf16_f32 v22, v40, v41
    ds_write_b32 v32, v22 offset:6528
    v_pk_mul_f32 v[42:43], v[38:39], v[14:15] op_sel_hi:[1,0]
    v_fma_f32 v42, -v15, v39, v42
    v_fma_f32 v43, v15, v38, v43
    v_cvt_pk_bf16_f32 v23, v42, -v43
    ds_write_b32 v32, v23 offset:272
    v_pk_mul_f32 v[44:45], v[36:37], v[36:37] op_sel_hi:[1,0]
    v_fma_f32 v44, -v37, v37, v44
    v_fma_f32 v45, v37, v36, v45
    v_cvt_pk_bf16_f32 v20, v44, v45
    ds_write_b32 v32, v20 offset:4896
    v_pk_mul_f32 v[46:47], v[38:39], v[42:43] op_sel_hi:[1,0]
    v_fma_f32 v46, -v43, v39, v46
    v_fma_f32 v47, v43, v38, v47
    v_cvt_pk_bf16_f32 v21, v46, -v47
    ds_write_b32 v32, v21 offset:544
    v_pk_mul_f32 v[48:49], v[36:37], v[44:45] op_sel_hi:[1,0]
    v_fma_f32 v48, -v45, v37, v48
    v_fma_f32 v49, v45, v36, v49
    v_cvt_pk_bf16_f32 v22, v48, v49
    ds_write_b32 v32, v22 offset:5168
    v_pk_mul_f32 v[50:51], v[38:39], v[46:47] op_sel_hi:[1,0]
    v_fma_f32 v50, -v47, v39, v50
    v_fma_f32 v51, v47, v38, v51
    v_cvt_pk_bf16_f32 v23, v50, -v51
    ds_write_b32 v32, v23 offset:816
    v_pk_mul_f32 v[52:53], v[36:37], v[48:49] op_sel_hi:[1,0]
    v_fma_f32 v52, -v49, v37, v52
    v_fma_f32 v53, v49, v36, v53
    v_cvt_pk_bf16_f32 v20, v52, v53
    ds_write_b32 v32, v20 offset:5440
    v_pk_mul_f32 v[54:55], v[38:39], v[50:51] op_sel_hi:[1,0]
    v_fma_f32 v54, -v51, v39, v54
    v_fma_f32 v55, v51, v38, v55
    v_cvt_pk_bf16_f32 v21, v54, -v55
    ds_write_b32 v32, v21 offset:1088
    v_pk_mul_f32 v[56:57], v[36:37], v[52:53] op_sel_hi:[1,0]
    v_fma_f32 v56, -v53, v37, v56
    v_fma_f32 v57, v53, v36, v57
    v_cvt_pk_bf16_f32 v22, v56, v57
    ds_write_b32 v32, v22 offset:5712
    v_pk_mul_f32 v[58:59], v[38:39], v[54:55] op_sel_hi:[1,0]
    v_fma_f32 v58, -v55, v39, v58
    v_fma_f32 v59, v55, v38, v59
    v_cvt_pk_bf16_f32 v23, v58, -v59
    ds_write_b32 v32, v23 offset:1360
    v_pk_mul_f32 v[60:61], v[36:37], v[56:57] op_sel_hi:[1,0]
    v_fma_f32 v60, -v57, v37, v60
    v_fma_f32 v61, v57, v36, v61
    v_cvt_pk_bf16_f32 v20, v60, v61
    ds_write_b32 v32, v20 offset:5984
    v_pk_mul_f32 v[62:63], v[38:39], v[58:59] op_sel_hi:[1,0]
    v_fma_f32 v62, -v59, v39, v62
    v_fma_f32 v63, v59, v38, v63
    v_cvt_pk_bf16_f32 v21, v62, -v63
    ds_write_b32 v32, v21 offset:1632
    v_pk_mul_f32 v[64:65], v[36:37], v[60:61] op_sel_hi:[1,0]
    v_fma_f32 v64, -v61, v37, v64
    v_fma_f32 v65, v61, v36, v65
    v_cvt_pk_bf16_f32 v22, v64, v65
    ds_write_b32 v32, v22 offset:6256
    v_pk_mul_f32 v[66:67], v[38:39], v[62:63] op_sel_hi:[1,0]
    v_fma_f32 v66, -v63, v39, v66
    v_fma_f32 v67, v63, v38, v67
    v_cvt_pk_bf16_f32 v23, v66, -v67
    ds_write_b32 v32, v23 offset:1904
    v_pk_mul_f32 v[68:69], v[40:41], v[36:37] op_sel_hi:[1,0]
    v_fma_f32 v68, -v37, v41, v68
    v_fma_f32 v69, v37, v40, v69
    v_cvt_pk_bf16_f32 v20, v68, v69
    ds_write_b32 v32, v20 offset:6800
    v_pk_mul_f32 v[70:71], v[38:39], v[66:67] op_sel_hi:[1,0]
    v_fma_f32 v70, -v67, v39, v70
    v_fma_f32 v71, v67, v38, v71
    v_cvt_pk_bf16_f32 v21, v70, -v71
    ds_write_b32 v32, v21 offset:2176
    v_pk_mul_f32 v[72:73], v[40:41], v[44:45] op_sel_hi:[1,0]
    v_fma_f32 v72, -v45, v41, v72
    v_fma_f32 v73, v45, v40, v73
    v_cvt_pk_bf16_f32 v22, v72, v73
    ds_write_b32 v32, v22 offset:7072
    v_pk_mul_f32 v[74:75], v[38:39], v[70:71] op_sel_hi:[1,0]
    v_fma_f32 v74, -v71, v39, v74
    v_fma_f32 v75, v71, v38, v75
    v_cvt_pk_bf16_f32 v23, v74, -v75
    ds_write_b32 v32, v23 offset:2448
    v_pk_mul_f32 v[76:77], v[40:41], v[48:49] op_sel_hi:[1,0]
    v_fma_f32 v76, -v49, v41, v76
    v_fma_f32 v77, v49, v40, v77
    v_cvt_pk_bf16_f32 v20, v76, v77
    ds_write_b32 v32, v20 offset:7344
    v_pk_mul_f32 v[78:79], v[38:39], v[74:75] op_sel_hi:[1,0]
    v_fma_f32 v78, -v75, v39, v78
    v_fma_f32 v79, v75, v38, v79
    v_cvt_pk_bf16_f32 v21, v78, -v79
    ds_write_b32 v32, v21 offset:2720
    v_pk_mul_f32 v[80:81], v[40:41], v[52:53] op_sel_hi:[1,0]
    v_fma_f32 v80, -v53, v41, v80
    v_fma_f32 v81, v53, v40, v81
    v_cvt_pk_bf16_f32 v22, v80, v81
    ds_write_b32 v32, v22 offset:7616
    v_pk_mul_f32 v[82:83], v[38:39], v[78:79] op_sel_hi:[1,0]
    v_fma_f32 v82, -v79, v39, v82
    v_fma_f32 v83, v79, v38, v83
    v_cvt_pk_bf16_f32 v23, v82, -v83
    ds_write_b32 v32, v23 offset:2992
    v_pk_mul_f32 v[84:85], v[40:41], v[56:57] op_sel_hi:[1,0]
    v_fma_f32 v84, -v57, v41, v84
    v_fma_f32 v85, v57, v40, v85
    v_cvt_pk_bf16_f32 v20, v84, v85
    ds_write_b32 v32, v20 offset:7888
    v_pk_mul_f32 v[86:87], v[38:39], v[82:83] op_sel_hi:[1,0]
    v_fma_f32 v86, -v83, v39, v86
    v_fma_f32 v87, v83, v38, v87
    v_cvt_pk_bf16_f32 v21, v86, -v87
    ds_write_b32 v32, v21 offset:3264
    v_pk_mul_f32 v[88:89], v[40:41], v[60:61] op_sel_hi:[1,0]
    v_fma_f32 v88, -v61, v41, v88
    v_fma_f32 v89, v61, v40, v89
    v_cvt_pk_bf16_f32 v22, v88, v89
    ds_write_b32 v32, v22 offset:8160
    v_pk_mul_f32 v[90:91], v[38:39], v[86:87] op_sel_hi:[1,0]
    v_fma_f32 v90, -v87, v39, v90
    v_fma_f32 v91, v87, v38, v91
    v_cvt_pk_bf16_f32 v23, v90, -v91
    ds_write_b32 v32, v23 offset:3536
    v_pk_mul_f32 v[92:93], v[40:41], v[64:65] op_sel_hi:[1,0]
    v_fma_f32 v92, -v65, v41, v92
    v_fma_f32 v93, v65, v40, v93
    v_cvt_pk_bf16_f32 v20, v92, v93
    ds_write_b32 v32, v20 offset:8432
    v_pk_mul_f32 v[94:95], v[38:39], v[90:91] op_sel_hi:[1,0]
    v_fma_f32 v94, -v91, v39, v94
    v_fma_f32 v95, v91, v38, v95
    v_cvt_pk_bf16_f32 v21, v94, -v95
    ds_write_b32 v32, v21 offset:3808
    v_pk_mul_f32 v[96:97], v[38:39], v[94:95] op_sel_hi:[1,0]
    v_fma_f32 v96, -v95, v39, v96
    v_fma_f32 v97, v95, v38, v97
    v_cvt_pk_bf16_f32 v22, v96, -v97
    ds_write_b32 v32, v22 offset:4080
    s_waitcnt lgkmcnt(0)
    ds_read_b128 v[104:107], v33 offset:0
    ds_read_b128 v[108:111], v33 offset:64
    ds_read_b128 v[112:115], v33 offset:128
    ds_read_b128 v[116:119], v33 offset:192
    ds_read_b128 v[120:123], v33 offset:4352
    ds_read_b128 v[124:127], v33 offset:4416
    ds_read_b128 v[128:131], v33 offset:4480
    ds_read_b128 v[132:135], v33 offset:4544
    v_pk_mul_f32 v[98:99], v[40:41], v[40:41] op_sel_hi:[1,0]
    v_fma_f32 v98, -v41, v41, v98
    v_fma_f32 v99, v41, v40, v99
    v_pk_mul_f32 v[100:101], v[40:41], v[98:99] op_sel_hi:[1,0]
    v_fma_f32 v100, -v99, v41, v100
    v_fma_f32 v101, v99, v40, v101
    v_pk_mul_f32 v[102:103], v[98:99], v[98:99] op_sel_hi:[1,0]
    v_fma_f32 v102, -v99, v99, v102
    v_fma_f32 v103, v99, v98, v103
    v_pk_mul_f32 v[42:43], v[44:45], v[98:99] op_sel_hi:[1,0]
    v_fma_f32 v42, -v99, v45, v42
    v_fma_f32 v43, v99, v44, v43
    v_pk_mul_f32 v[46:47], v[52:53], v[98:99] op_sel_hi:[1,0]
    v_fma_f32 v46, -v99, v53, v46
    v_fma_f32 v47, v99, v52, v47
    v_pk_mul_f32 v[50:51], v[60:61], v[98:99] op_sel_hi:[1,0]
    v_fma_f32 v50, -v99, v61, v50
    v_fma_f32 v51, v99, v60, v51
    v_pk_mul_f32 v[54:55], v[44:45], v[100:101] op_sel_hi:[1,0]
    v_fma_f32 v54, -v101, v45, v54
    v_fma_f32 v55, v101, v44, v55
    v_pk_mul_f32 v[58:59], v[52:53], v[100:101] op_sel_hi:[1,0]
    v_fma_f32 v58, -v101, v53, v58
    v_fma_f32 v59, v101, v52, v59
    v_pk_mul_f32 v[62:63], v[60:61], v[100:101] op_sel_hi:[1,0]
    v_fma_f32 v62, -v101, v61, v62
    v_fma_f32 v63, v101, v60, v63
    v_pk_mul_f32 v[68:69], v[40:41], v[102:103] op_sel_hi:[1,0]
    v_fma_f32 v68, -v103, v41, v68
    v_fma_f32 v69, v103, v40, v69
    v_pk_mul_f32 v[66:67], v[98:99], v[102:103] op_sel_hi:[1,0]
    v_fma_f32 v66, -v103, v99, v66
    v_fma_f32 v67, v103, v98, v67
    v_pk_mul_f32 v[72:73], v[100:101], v[102:103] op_sel_hi:[1,0]
    v_fma_f32 v72, -v103, v101, v72
    v_fma_f32 v73, v103, v100, v73
    v_pk_mul_f32 v[70:71], v[52:53], v[102:103] op_sel_hi:[1,0]
    v_fma_f32 v70, -v103, v53, v70
    v_fma_f32 v71, v103, v52, v71
    v_pk_mul_f32 v[76:77], v[52:53], v[68:69] op_sel_hi:[1,0]
    v_fma_f32 v76, -v69, v53, v76
    v_fma_f32 v77, v69, v52, v77
    v_pk_mul_f32 v[74:75], v[52:53], v[66:67] op_sel_hi:[1,0]
    v_fma_f32 v74, -v67, v53, v74
    v_fma_f32 v75, v67, v52, v75
    v_pk_mul_f32 v[80:81], v[52:53], v[72:73] op_sel_hi:[1,0]
    v_fma_f32 v80, -v73, v53, v80
    v_fma_f32 v81, v73, v52, v81
    s_waitcnt lgkmcnt(0)
    v_mfma_f32_16x16x32_bf16 v[136:139], v[120:123], v[104:107], 0
    v_mfma_f32_16x16x32_bf16 v[136:139], v[124:127], v[108:111], v[136:139]
    v_mfma_f32_16x16x32_bf16 v[136:139], v[128:131], v[112:115], v[136:139]
    v_mfma_f32_16x16x32_bf16 v[136:139], v[132:135], v[116:119], v[136:139]
    v_cvt_pk_bf16_f32 v23, v98, v99
    ds_write_b32 v32, v23 offset:4352
    v_cvt_pk_bf16_f32 v20, v42, v43
    ds_write_b32 v32, v20 offset:4624
    v_cvt_pk_bf16_f32 v21, v46, v47
    ds_write_b32 v32, v21 offset:4896
    v_cvt_pk_bf16_f32 v22, v50, v51
    ds_write_b32 v32, v22 offset:5168
    v_cvt_pk_bf16_f32 v23, v100, v101
    ds_write_b32 v32, v23 offset:5440
    v_cvt_pk_bf16_f32 v20, v54, v55
    ds_write_b32 v32, v20 offset:5712
    v_cvt_pk_bf16_f32 v21, v58, v59
    ds_write_b32 v32, v21 offset:5984
    v_cvt_pk_bf16_f32 v22, v62, v63
    ds_write_b32 v32, v22 offset:6256
    v_cvt_pk_bf16_f32 v23, v102, v103
    ds_write_b32 v32, v23 offset:6528
    v_cvt_pk_bf16_f32 v20, v70, v71
    ds_write_b32 v32, v20 offset:6800
    v_cvt_pk_bf16_f32 v21, v68, v69
    ds_write_b32 v32, v21 offset:7072
    v_cvt_pk_bf16_f32 v22, v76, v77
    ds_write_b32 v32, v22 offset:7344
    v_cvt_pk_bf16_f32 v23, v66, v67
    ds_write_b32 v32, v23 offset:7616
    v_cvt_pk_bf16_f32 v20, v74, v75
    ds_write_b32 v32, v20 offset:7888
    v_cvt_pk_bf16_f32 v21, v72, v73
    ds_write_b32 v32, v21 offset:8160
    v_cvt_pk_bf16_f32 v22, v80, v81
    ds_write_b32 v32, v22 offset:8432
    s_waitcnt lgkmcnt(0)
    ds_read_b128 v[120:123], v33 offset:4352
    ds_read_b128 v[124:127], v33 offset:4416
    ds_read_b128 v[128:131], v33 offset:4480
    ds_read_b128 v[132:135], v33 offset:4544
    v_pk_mul_f32 v[78:79], v[102:103], v[102:103] op_sel_hi:[1,0]
    v_fma_f32 v78, -v103, v103, v78
    v_fma_f32 v79, v103, v102, v79
    v_pk_mul_f32 v[84:85], v[40:41], v[78:79] op_sel_hi:[1,0]
    v_fma_f32 v84, -v79, v41, v84
    v_fma_f32 v85, v79, v40, v85
    v_pk_mul_f32 v[82:83], v[40:41], v[84:85] op_sel_hi:[1,0]
    v_fma_f32 v82, -v85, v41, v82
    v_fma_f32 v83, v85, v40, v83
    v_pk_mul_f32 v[88:89], v[40:41], v[82:83] op_sel_hi:[1,0]
    v_fma_f32 v88, -v83, v41, v88
    v_fma_f32 v89, v83, v40, v89
    v_pk_mul_f32 v[86:87], v[40:41], v[88:89] op_sel_hi:[1,0]
    v_fma_f32 v86, -v89, v41, v86
    v_fma_f32 v87, v89, v40, v87
    v_pk_mul_f32 v[92:93], v[40:41], v[86:87] op_sel_hi:[1,0]
    v_fma_f32 v92, -v87, v41, v92
    v_fma_f32 v93, v87, v40, v93
    v_pk_mul_f32 v[90:91], v[40:41], v[92:93] op_sel_hi:[1,0]
    v_fma_f32 v90, -v93, v41, v90
    v_fma_f32 v91, v93, v40, v91
    v_pk_mul_f32 v[94:95], v[40:41], v[90:91] op_sel_hi:[1,0]
    v_fma_f32 v94, -v91, v41, v94
    v_fma_f32 v95, v91, v40, v95
    v_pk_mul_f32 v[96:97], v[78:79], v[78:79] op_sel_hi:[1,0]
    v_fma_f32 v96, -v79, v79, v96
    v_fma_f32 v97, v79, v78, v97
    s_waitcnt lgkmcnt(0)
    v_mfma_f32_16x16x32_bf16 v[140:143], v[120:123], v[104:107], 0
    v_mfma_f32_16x16x32_bf16 v[140:143], v[124:127], v[108:111], v[140:143]
    v_mfma_f32_16x16x32_bf16 v[140:143], v[128:131], v[112:115], v[140:143]
    v_mfma_f32_16x16x32_bf16 v[140:143], v[132:135], v[116:119], v[140:143]
    v_cvt_pk_bf16_f32 v23, v78, v79
    ds_write_b32 v32, v23 offset:4352
    v_cvt_pk_bf16_f32 v20, v84, v85
    ds_write_b32 v32, v20 offset:4624
    v_cvt_pk_bf16_f32 v21, v82, v83
    ds_write_b32 v32, v21 offset:4896
    v_cvt_pk_bf16_f32 v22, v88, v89
    ds_write_b32 v32, v22 offset:5168
    v_cvt_pk_bf16_f32 v23, v86, v87
    ds_write_b32 v32, v23 offset:5440
    v_cvt_pk_bf16_f32 v20, v92, v93
    ds_write_b32 v32, v20 offset:5712
    v_cvt_pk_bf16_f32 v21, v90, v91
    ds_write_b32 v32, v21 offset:5984
    v_cvt_pk_bf16_f32 v22, v94, v95
    ds_write_b32 v32, v22 offset:6256
    v_cvt_pk_bf16_f32 v23, v96, v97
    ds_write_b32 v32, v23 offset:6528
    s_waitcnt lgkmcnt(0)
    ds_read_b128 v[120:123], v33 offset:4352
    ds_read_b128 v[124:127], v33 offset:4416
    ds_read_b128 v[128:131], v33 offset:4480
    ds_read_b128 v[132:135], v33 offset:4544
    s_waitcnt lgkmcnt(0)
    v_mfma_f32_16x16x32_bf16 v[144:147], v[120:123], v[104:107], 0
    v_mfma_f32_16x16x32_bf16 v[144:147], v[124:127], v[108:111], v[144:147]
    v_mfma_f32_16x16x32_bf16 v[144:147], v[128:131], v[112:115], v[144:147]
    v_mfma_f32_16x16x32_bf16 v[144:147], v[132:135], v[116:119], v[144:147]
    v_lshlrev_b32 v34, 4, v1
    v_add_u32 v35, s8, v34
    ds_write_b128 v35, v[136:139] offset:0
    ds_write_b128 v35, v[140:143] offset:1024
    s_nop 3
    ds_write_b128 v35, v[144:147] offset:2048
    s_waitcnt lgkmcnt(0)
    s_barrier
    s_cmp_eq_u32 s4, 3
    s_cbranch_scc1 k12c_sc_done
    s_lshl_b32 s9, s4, 10
    v_add_u32 v35, s9, v34
    ds_read_b128 v[36:39], v35 offset:0
    ds_read_b128 v[40:43], v35 offset:8704
    ds_read_b128 v[44:47], v35 offset:17408
    ds_read_b128 v[48:51], v35 offset:26112
    v_mov_b32 v35, 0
    ds_read_b32 v52, v35 offset:1024
    ds_read_b32 v53, v35 offset:9728
    ds_read_b32 v54, v35 offset:18432
    ds_read_b32 v55, v35 offset:27136
    s_waitcnt lgkmcnt(0)
    v_pk_add_f32 v[36:37], v[36:37], v[40:41]
    v_pk_add_f32 v[44:45], v[44:45], v[48:49]
    v_pk_add_f32 v[38:39], v[38:39], v[42:43]
    v_pk_add_f32 v[46:47], v[46:47], v[50:51]
    v_pk_add_f32 v[36:37], v[36:37], v[44:45]
    v_pk_add_f32 v[38:39], v[38:39], v[46:47]
    s_cmp_eq_u32 s4, 1
    s_nop 0
    s_cbranch_scc1 k12c_sc1
    s_cmp_eq_u32 s4, 2
    s_cbranch_scc1 k12c_sc2
    v_add_f32 v52, v52, v53
    v_add_f32 v54, v54, v55
    v_add_f32 v52, v52, v54
    v_cmp_eq_u32 vcc, 63, v1
    s_nop 1
    v_cndmask_b32 v52, 0, v52, vcc
    v_sub_f32 v39, v39, v52
    v_cvt_pk_bf16_f32 v40, v36, v36
    v_cvt_pk_bf16_f32 v41, v37, v37
    v_cvt_pk_bf16_f32 v42, v38, v38
    v_cvt_pk_bf16_f32 v43, v39, v39
    ds_write_b16 v28, v40 offset:35094
    ds_write_b16 v28, v40 offset:37268
    ds_write_b16 v28, v40 offset:39442
    ds_write_b16 v28, v40 offset:41616
    ds_write_b16 v28, v41 offset:35092
    ds_write_b16 v28, v41 offset:37266
    ds_write_b16 v28, v41 offset:39440
    ds_write_b16 v28, v41 offset:41614
    ds_write_b16 v28, v42 offset:35090
    ds_write_b16 v28, v42 offset:37264
    ds_write_b16 v28, v42 offset:39438
    ds_write_b16 v28, v42 offset:41612
    ds_write_b16 v28, v43 offset:35088
    ds_write_b16 v28, v43 offset:37262
    ds_write_b16 v28, v43 offset:39436
    ds_write_b16 v28, v43 offset:41610
    s_branch k12c_sc_done
k12c_sc1:
    v_readlane_b32 s10, v36, 32
    v_cmp_eq_u32 vcc, 31, v1
    s_nop 0
    v_mov_b32 v52, s10
    v_cndmask_b32 v52, 0, v52, vcc
    v_sub_f32 v39, v39, v52
    v_cvt_pk_bf16_f32 v40, v36, v36
    v_cvt_pk_bf16_f32 v41, v37, v37
    v_cvt_pk_bf16_f32 v42, v38, v38
    v_cvt_pk_bf16_f32 v43, v39, v39
    ds_write_b16 v29, v40 offset:35088
    ds_write_b16 v29, v40 offset:37262
    ds_write_b16 v29, v40 offset:39436
    ds_write_b16 v29, v40 offset:41610
    ds_write_b16 v29, v41 offset:35344
    ds_write_b16 v29, v41 offset:37518
    ds_write_b16 v29, v41 offset:39692
    ds_write_b16 v29, v41 offset:41866
    ds_write_b16 v30, v42 offset:35088
    ds_write_b16 v30, v42 offset:37262
    ds_write_b16 v30, v42 offset:39436
    ds_write_b16 v30, v42 offset:41610
    ds_write_b16 v30, v43 offset:35344
    ds_write_b16 v30, v43 offset:37518
    ds_write_b16 v30, v43 offset:39692
    ds_write_b16 v30, v43 offset:41866
    s_branch k12c_sc_done
k12c_sc2:
    v_cvt_pk_bf16_f32 v40, v36, v36
    v_cvt_pk_bf16_f32 v41, v37, v37
    v_cvt_pk_bf16_f32 v42, v38, v38
    v_cvt_pk_bf16_f32 v43, v39, v39
    s_mov_b64 exec, 1
    v_mov_b32 v52, 43904
    ds_write_b32 v52, v36
    s_mov_b32 exec_lo, -2
    s_mov_b32 exec_hi, 0x0000ffff
    ds_write_b16 v31, v40 offset:35136
    ds_write_b16 v31, v40 offset:37310
    ds_write_b16 v31, v40 offset:39484
    ds_write_b16 v31, v40 offset:41658
    s_mov_b32 exec_lo, -1
    s_mov_b32 exec_hi, 0
    ds_write_b16 v31, v41 offset:35120
    ds_write_b16 v31, v41 offset:37294
    ds_write_b16 v31, v41 offset:39468
    ds_write_b16 v31, v41 offset:41642
    ds_write_b16 v31, v42 offset:35104
    ds_write_b16 v31, v42 offset:37278
    ds_write_b16 v31, v42 offset:39452
    ds_write_b16 v31, v42 offset:41626
    ds_write_b16 v31, v43 offset:35088
    ds_write_b16 v31, v43 offset:37262
    ds_write_b16 v31, v43 offset:39436
    ds_write_b16 v31, v43 offset:41610
    s_mov_b64 exec, -1
k12c_sc_done:
    s_waitcnt lgkmcnt(0)
    s_add_u32 s48, s46, 0x10000
    s_addc_u32 s49, s47, 0
    s_mov_b32 s50, 0x2000
    s_mov_b32 s51, 0x20000
    s_add_u32 s52, s46, 0x200000
    s_addc_u32 s53, s47, 0
    s_mov_b32 s54, 0x1c0000
    s_mov_b32 s55, 0x20000
    s_mov_b32 s56, s46
    s_mov_b32 s57, s47
    s_mov_b32 s58, 0x2a00
    s_mov_b32 s59, 0x20000
    s_add_u32 s60, s46, 0x500000
    s_addc_u32 s61, s47, 0
    s_mov_b32 s62, 0x1c0000
    s_mov_b32 s63, 0x20000
    s_barrier
    v_mov_b32 v11, 43904
    ds_read_b32 v161, v11
    v_lshlrev_b32 v6, 4, v0
    v_and_b32 v3, 15, v1
    v_lshrrev_b32 v4, 4, v1
    v_lshlrev_b32 v5, 3, v4
    v_sub_u32 v5, v5, v3
    v_add_u32 v5, 15, v5
    v_and_b32 v8, 3, v5
    v_sub_u32 v5, v5, v8
    v_lshlrev_b32 v5, 1, v5
    v_mul_u32_u24 v8, 2176, v8
    v_add_u32 v5, v5, v8
    v_add_u32 v5, 35088, v5
    s_cmp_eq_u32 s4, 2
    s_nop 0
    s_cbranch_scc1 k12c_tf2
    s_cmp_eq_u32 s4, 3
    s_cbranch_scc1 k12c_tf3
    ds_read2_b64 v[104:107], v5 offset0:0 offset1:1
    ds_read2_b64 v[108:111], v5 offset0:8 offset1:9
    ds_read2_b64 v[112:115], v5 offset0:16 offset1:17
    ds_read2_b64 v[116:119], v5 offset0:24 offset1:25
    ds_read2_b64 v[120:123], v5 offset0:32 offset1:33
    ds_read2_b64 v[124:127], v5 offset0:40 offset1:41
    ds_read2_b64 v[128:131], v5 offset0:48 offset1:49
    ds_read2_b64 v[132:135], v5 offset0:56 offset1:57
    ds_read2_b64 v[136:139], v5 offset0:64 offset1:65
    s_branch k12c_tfx
k12c_tf2:
    ds_read2_b64 v[104:107], v5 offset0:80 offset1:81
    ds_read2_b64 v[108:111], v5 offset0:88 offset1:89
    ds_read2_b64 v[112:115], v5 offset0:96 offset1:97
    ds_read2_b64 v[116:119], v5 offset0:112 offset1:113
    ds_read2_b64 v[120:123], v5 offset0:120 offset1:121
    ds_read2_b64 v[124:127], v5 offset0:128 offset1:129
    s_branch k12c_tfx
k12c_tf3:
    v_add_u32 v5, 1152, v5
    ds_read2_b64 v[104:107], v5 offset0:0 offset1:1
    ds_read2_b64 v[108:111], v5 offset0:8 offset1:9
    ds_read2_b64 v[112:115], v5 offset0:16 offset1:17
    ds_read2_b64 v[116:119], v5 offset0:32 offset1:33
    ds_read2_b64 v[120:123], v5 offset0:40 offset1:41
    ds_read2_b64 v[124:127], v5 offset0:48 offset1:49
    ds_read2_b64 v[128:131], v5 offset0:64 offset1:65
    ds_read2_b64 v[132:135], v5 offset0:72 offset1:73
    ds_read2_b64 v[136:139], v5 offset0:80 offset1:81
    ds_read2_b64 v[140:143], v5 offset0:96 offset1:97
    ds_read2_b64 v[144:147], v5 offset0:104 offset1:105
    ds_read2_b64 v[148:151], v5 offset0:112 offset1:113
k12c_tfx:
    v_mov_b32 v12, 0
    v_mov_b32 v13, 0
    v_mov_b32 v14, 0
    v_mov_b32 v15, 0
    v_cmp_gt_u32 vcc, 51, v0
    s_nop 0
    s_and_saveexec_b64 s[12:13], vcc
    s_nop 2
    s_cbranch_execz k12c_z_0
    ds_write_b128 v6, v[12:15] offset:0
k12c_z_0:
    s_mov_b64 exec, s[12:13]
    v_cmp_gt_u32 vcc, 80, v0
    s_nop 0
    s_and_saveexec_b64 s[12:13], vcc
    s_nop 2
    s_cbranch_execz k12c_z_5184
    ds_write_b128 v6, v[12:15] offset:5184
k12c_z_5184:
    s_mov_b64 exec, s[12:13]
    v_cmp_gt_u32 vcc, 39, v0
    s_nop 0
    s_and_saveexec_b64 s[12:13], vcc
    s_nop 2
    s_cbranch_execz k12c_z_10080
    ds_write_b128 v6, v[12:15] offset:10080
k12c_z_10080:
    s_mov_b64 exec, s[12:13]
    v_cmp_gt_u32 vcc, 79, v0
    s_nop 0
    s_and_saveexec_b64 s[12:13], vcc
    s_nop 2
    s_cbranch_execz k12c_z_14320
    ds_write_b128 v6, v[12:15] offset:14320
k12c_z_14320:
    s_mov_b64 exec, s[12:13]
    v_cmp_gt_u32 vcc, 64, v0
    s_nop 0
    s_and_saveexec_b64 s[12:13], vcc
    s_nop 2
    s_cbranch_execz k12c_z_18688
    ds_write_b128 v6, v[12:15] offset:18688
k12c_z_18688:
    s_mov_b64 exec, s[12:13]
    v_cmp_gt_u32 vcc, 63, v0
    s_nop 0
    s_and_saveexec_b64 s[12:13], vcc
    s_nop 2
    s_cbranch_execz k12c_z_21792
    ds_write_b128 v6, v[12:15] offset:21792
k12c_z_21792:
    s_mov_b64 exec, s[12:13]
    v_lshrrev_b32 v7, 4, v0
    v_lshl_add_u32 v7, v7, 4, v6
    v_add_u32 v16, 47, v0
    v_lshrrev_b32 v16, 4, v16
    v_lshl_add_u32 v16, v16, 4, v6
    v_add_u32 v17, 46, v0
    v_lshrrev_b32 v17, 4, v17
    v_lshl_add_u32 v17, v17, 4, v6
    v_lshlrev_b32 v5, 5, v0
    s_lshl_b32 s9, s5, 12
    s_lshl_b32 s6, s5, 2
    s_waitcnt lgkmcnt(0)
    s_cmp_lg_u32 s4, 0
    s_cbranch_scc1 wt_chAB_done
    s_mov_b32 s78, 4194304
wt_chAB_loop:
    buffer_load_dwordx4 v[156:159], off, s[72:75], 0 offset:128 sc1
    s_waitcnt vmcnt(0)
    v_and_b32 v2, v156, v157
    v_and_b32 v2, v2, v158
    s_nop 0
    v_readfirstlane_b32 s79, v2
    s_nop 0
    s_cmp_lg_u32 s79, 0
    s_nop 2
    s_cbranch_scc1 wt_chAB_done
    s_sub_u32 s78, s78, 1
    s_cmp_eq_u32 s78, 0
    s_cbranch_scc1 wt_chAB_done
    s_sleep 6
    s_cmp_gt_u32 s78, 4194301
    s_cbranch_scc1 wt_chAB_loop
    s_sleep 12
    s_branch wt_chAB_loop
wt_chAB_done:
    s_barrier
    buffer_load_dwordx4 v[152:155], v6, s[52:55], s9 offen sc1
    buffer_load_dwordx4 v[56:59], v5, s[48:51], 0 offen offset:0 sc1
    buffer_load_dwordx4 v[60:63], v5, s[48:51], 0 offen offset:16 sc1
    buffer_load_dword v20, off, s[56:59], s6 sc1
    buffer_load_dword v18, off, s[56:59], s6 offset:1792 sc1
    buffer_load_dword v162, off, s[56:59], s6 offset:3584 sc1
    s_waitcnt vmcnt(3)
    v_lshlrev_b32 v40, 16, v56
    v_and_b32 v41, 0xffff0000, v56
    v_lshlrev_b32 v42, 16, v57
    v_and_b32 v43, 0xffff0000, v57
    v_lshlrev_b32 v44, 16, v58
    v_and_b32 v45, 0xffff0000, v58
    v_lshlrev_b32 v46, 16, v59
    v_and_b32 v47, 0xffff0000, v59
    v_lshlrev_b32 v48, 16, v60
    v_and_b32 v49, 0xffff0000, v60
    v_lshlrev_b32 v50, 16, v61
    v_and_b32 v51, 0xffff0000, v61
    v_lshlrev_b32 v52, 16, v62
    v_and_b32 v53, 0xffff0000, v62
    v_lshlrev_b32 v54, 16, v63
    v_and_b32 v55, 0xffff0000, v63
    v_rcp_f32 v41, v41
    v_rcp_f32 v43, v43
    v_rcp_f32 v45, v45
    v_rcp_f32 v47, v47
    v_rcp_f32 v49, v49
    v_rcp_f32 v51, v51
    v_rcp_f32 v53, v53
    v_rcp_f32 v55, v55
    v_lshlrev_b32 v24, 16, v152
    v_and_b32 v25, 0xffff0000, v152
    v_lshlrev_b32 v26, 16, v153
    v_and_b32 v27, 0xffff0000, v153
    v_lshlrev_b32 v28, 16, v154
    v_and_b32 v29, 0xffff0000, v154
    v_lshlrev_b32 v30, 16, v155
    v_and_b32 v31, 0xffff0000, v155
    v_sub_f32 v24, v24, v40
    v_sub_f32 v25, v25, v42
    v_sub_f32 v26, v26, v44
    v_sub_f32 v27, v27, v46
    v_sub_f32 v28, v28, v48
    v_sub_f32 v29, v29, v50
    v_sub_f32 v30, v30, v52
    v_sub_f32 v31, v31, v54
    v_cvt_pk_bf16_f32 v8, v24, v25
    v_cvt_pk_bf16_f32 v9, v26, v27
    v_cvt_pk_bf16_f32 v10, v28, v29
    v_cvt_pk_bf16_f32 v11, v30, v31
    v_lshlrev_b32 v24, 16, v8
    v_and_b32 v25, 0xffff0000, v8
    v_lshlrev_b32 v26, 16, v9
    v_and_b32 v27, 0xffff0000, v9
    v_lshlrev_b32 v28, 16, v10
    v_and_b32 v29, 0xffff0000, v10
    v_lshlrev_b32 v30, 16, v11
    v_and_b32 v31, 0xffff0000, v11
    v_mul_f32 v24, v24, v41
    v_mul_f32 v25, v25, v43
    v_mul_f32 v26, v26, v45
    v_mul_f32 v27, v27, v47
    v_mul_f32 v28, v28, v49
    v_mul_f32 v29, v29, v51
    v_mul_f32 v30, v30, v53
    v_mul_f32 v31, v31, v55
    v_cvt_pk_bf16_f32 v8, v24, v25
    v_cvt_pk_bf16_f32 v9, v26, v27
    v_cvt_pk_bf16_f32 v10, v28, v29
    v_cvt_pk_bf16_f32 v11, v30, v31
    v_lshlrev_b32 v24, 16, v8
    v_and_b32 v25, 0xffff0000, v8
    v_lshlrev_b32 v26, 16, v9
    v_and_b32 v27, 0xffff0000, v9
    v_lshlrev_b32 v28, 16, v10
    v_and_b32 v29, 0xffff0000, v10
    v_lshlrev_b32 v30, 16, v11
    v_and_b32 v31, 0xffff0000, v11
    s_waitcnt vmcnt(0)
    v_add_f32 v18, 1.0, v18
    v_cvt_pk_bf16_f32 v18, v18, v18
    v_lshlrev_b32 v18, 16, v18
    v_pk_mul_f32 v[24:25], v[24:25], v[18:19] op_sel_hi:[1,0]
    v_pk_mul_f32 v[26:27], v[26:27], v[18:19] op_sel_hi:[1,0]
    v_pk_mul_f32 v[28:29], v[28:29], v[18:19] op_sel_hi:[1,0]
    v_pk_mul_f32 v[30:31], v[30:31], v[18:19] op_sel_hi:[1,0]
    v_cvt_pk_bf16_f32 v8, v24, v25
    v_cvt_pk_bf16_f32 v9, v26, v27
    v_cvt_pk_bf16_f32 v10, v28, v29
    v_cvt_pk_bf16_f32 v11, v30, v31
    v_lshlrev_b32 v24, 16, v8
    v_and_b32 v25, 0xffff0000, v8
    v_lshlrev_b32 v26, 16, v9
    v_and_b32 v27, 0xffff0000, v9
    v_lshlrev_b32 v28, 16, v10
    v_and_b32 v29, 0xffff0000, v10
    v_lshlrev_b32 v30, 16, v11
    v_and_b32 v31, 0xffff0000, v11
    v_pk_add_f32 v[24:25], v[24:25], v[20:21] op_sel_hi:[1,0]
    v_pk_add_f32 v[26:27], v[26:27], v[20:21] op_sel_hi:[1,0]
    v_pk_add_f32 v[28:29], v[28:29], v[20:21] op_sel_hi:[1,0]
    v_pk_add_f32 v[30:31], v[30:31], v[20:21] op_sel_hi:[1,0]
    v_cvt_pk_bf16_f32 v8, v24, v25
    v_cvt_pk_bf16_f32 v9, v26, v27
    v_cvt_pk_bf16_f32 v10, v28, v29
    v_cvt_pk_bf16_f32 v11, v30, v31
    ds_write_b128 v7, v[8:11] offset:816
    v_lshlrev_b32 v24, 16, v8
    v_and_b32 v25, 0xffff0000, v8
    v_lshlrev_b32 v26, 16, v9
    v_and_b32 v27, 0xffff0000, v9
    v_lshlrev_b32 v28, 16, v10
    v_and_b32 v29, 0xffff0000, v10
    v_lshlrev_b32 v30, 16, v11
    v_and_b32 v31, 0xffff0000, v11
    s_waitcnt lgkmcnt(0)
    s_barrier
    ds_read_b64 v[8:9], v17 offset:744
    ds_read_b128 v[10:13], v16 offset:752
    ds_read_b64 v[14:15], v7 offset:816
    s_waitcnt lgkmcnt(0)
    v_lshlrev_b32 v32, 16, v8
    v_and_b32 v33, 0xffff0000, v8
    v_lshlrev_b32 v34, 16, v9
    v_and_b32 v35, 0xffff0000, v9
    v_lshlrev_b32 v36, 16, v10
    v_and_b32 v37, 0xffff0000, v10
    v_lshlrev_b32 v38, 16, v11
    v_and_b32 v39, 0xffff0000, v11
    v_lshlrev_b32 v40, 16, v12
    v_and_b32 v41, 0xffff0000, v12
    v_lshlrev_b32 v42, 16, v13
    v_and_b32 v43, 0xffff0000, v13
    v_lshlrev_b32 v44, 16, v14
    v_and_b32 v45, 0xffff0000, v14
    v_lshlrev_b32 v46, 16, v15
    v_and_b32 v47, 0xffff0000, v15
    v_mov_b32 v96, v9
    v_mov_b32 v97, v10
    v_mov_b32 v98, v11
    v_mov_b32 v99, v12
    v_add_f32 v48, v32, v33
    v_add_f32 v49, v33, v34
    v_add_f32 v50, v34, v35
    v_add_f32 v51, v35, v36
    v_add_f32 v52, v36, v37
    v_add_f32 v53, v37, v38
    v_add_f32 v54, v38, v39
    v_add_f32 v55, v39, v40
    v_add_f32 v56, v40, v41
    v_add_f32 v57, v41, v42
    v_add_f32 v58, v42, v43
    v_add_f32 v59, v43, v44
    v_add_f32 v60, v44, v45
    v_add_f32 v61, v45, v46
    v_add_f32 v74, v51, v37
    v_add_f32 v75, v52, v38
    v_add_f32 v76, v53, v39
    v_add_f32 v77, v54, v40
    v_add_f32 v78, v55, v41
    v_add_f32 v79, v56, v42
    v_add_f32 v80, v57, v43
    v_add_f32 v81, v58, v44
    v_add_f32 v82, v59, v45
    v_add_f32 v83, v60, v46
    v_pk_add_f32 v[62:63], v[48:49], v[50:51]
    v_pk_add_f32 v[64:65], v[50:51], v[52:53]
    v_pk_add_f32 v[66:67], v[52:53], v[54:55]
    v_pk_add_f32 v[68:69], v[54:55], v[56:57]
    v_pk_add_f32 v[70:71], v[56:57], v[58:59]
    v_pk_add_f32 v[72:73], v[58:59], v[60:61]
    v_pk_add_f32 v[84:85], v[64:65], v[38:39]
    v_pk_add_f32 v[86:87], v[66:67], v[40:41]
    v_pk_add_f32 v[88:89], v[68:69], v[42:43]
    v_pk_add_f32 v[90:91], v[70:71], v[44:45]
    v_pk_add_f32 v[92:93], v[72:73], v[46:47]
    v_add_f32 v48, v62, v75
    v_add_f32 v49, v63, v76
    v_add_f32 v50, v64, v77
    v_add_f32 v51, v65, v78
    v_add_f32 v52, v66, v79
    v_add_f32 v53, v67, v80
    v_add_f32 v54, v68, v81
    v_add_f32 v55, v69, v82
    v_add_f32 v56, v70, v83
    v_pk_add_f32 v[32:33], v[62:63], v[86:87]
    v_pk_add_f32 v[34:35], v[64:65], v[88:89]
    v_pk_add_f32 v[36:37], v[66:67], v[90:91]
    v_pk_add_f32 v[38:39], v[68:69], v[92:93]
    v_cvt_pk_bf16_f32 v8, v74, v75
    v_cvt_pk_bf16_f32 v9, v76, v77
    v_cvt_pk_bf16_f32 v10, v78, v79
    v_cvt_pk_bf16_f32 v11, v80, v81
    v_cvt_pk_bf16_f32 v12, v84, v85
    v_cvt_pk_bf16_f32 v13, v86, v87
    v_cvt_pk_bf16_f32 v14, v88, v89
    v_cvt_pk_bf16_f32 v15, v90, v91
    v_cvt_pk_bf16_f32 v40, v49, v50
    v_cvt_pk_bf16_f32 v41, v51, v52
    v_cvt_pk_bf16_f32 v42, v53, v54
    v_cvt_pk_bf16_f32 v43, v55, v56
    v_cvt_pk_bf16_f32 v44, v32, v33
    v_cvt_pk_bf16_f32 v45, v34, v35
    v_cvt_pk_bf16_f32 v46, v36, v37
    v_cvt_pk_bf16_f32 v47, v38, v39
    v_cvt_pk_bf16_f32 v60, v48, v49
    v_cvt_pk_bf16_f32 v61, v50, v51
    v_cvt_pk_bf16_f32 v62, v52, v53
    v_cvt_pk_bf16_f32 v63, v54, v55
    v_cmp_gt_u32 vcc, 225, v0
    s_nop 0
    s_and_saveexec_b64 s[12:13], vcc
    s_nop 2
    s_cbranch_execz k12c_w0
    ds_write_b128 v6, v[8:11] offset:6464
    ds_write_b128 v6, v[96:99] offset:10704
k12c_w0:
    s_mov_b64 exec, s[12:13]
    v_cmp_gt_u32 vcc, 193, v0
    s_nop 0
    s_and_saveexec_b64 s[12:13], vcc
    s_nop 2
    s_cbranch_execz k12c_w1
    ds_write_b128 v6, v[12:15] offset:15584
k12c_w1:
    s_mov_b64 exec, s[12:13]
    v_cmp_gt_u32 vcc, 129, v0
    s_nop 0
    s_and_saveexec_b64 s[12:13], vcc
    s_nop 2
    s_cbranch_execz k12c_w2
    ds_write_b128 v6, v[40:43] offset:19712
    ds_write_b128 v6, v[44:47] offset:22800
    ds_write_b128 v6, v[60:63] offset:24880
k12c_w2:
    s_mov_b64 exec, s[12:13]
    s_waitcnt lgkmcnt(0)
    v_bfe_u32 v8, v1, 2, 2
    v_and_b32 v9, 3, v1
    v_lshl_add_u32 v10, v4, 3, v8
    s_cmp_eq_u32 s4, 2
    s_nop 0
    s_cbranch_scc1 k12c_seg1
    s_cmp_eq_u32 s4, 3
    s_cbranch_scc1 k12c_seg23
    s_lshl_b32 s7, s4, 4
    v_lshlrev_b32 v11, 3, v4
    v_add_u32 v11, s7, v11
    v_mul_u32_u24 v12, 272, v3
    v_lshl_add_u32 v12, v11, 1, v12
    v_cmp_le_u32 vcc, 16, v11
    v_add_u32 v13, 16, v12
    s_nop 0
    v_cndmask_b32 v13, v12, v13, vcc
    s_barrier
    ds_read_b128 v[32:35], v13 offset:224
    ds_read_b128 v[36:39], v12 offset:304
    ds_read_b128 v[40:43], v12 offset:368
    ds_read_b128 v[44:47], v12 offset:432
    ds_read_b128 v[48:51], v13 offset:496
    s_waitcnt lgkmcnt(4)
    v_mfma_f32_16x16x32_bf16 v[64:67], v[104:107], v[32:35], 0
    ds_read_b128 v[52:55], v12 offset:576
    s_waitcnt lgkmcnt(4)
    v_mfma_f32_16x16x32_bf16 v[64:67], v[108:111], v[36:39], v[64:67]
    v_mfma_f32_16x16x32_bf16 v[68:71], v[104:107], v[36:39], 0
    ds_read_b128 v[56:59], v12 offset:640
    s_waitcnt lgkmcnt(4)
    v_mfma_f32_16x16x32_bf16 v[64:67], v[112:115], v[40:43], v[64:67]
    v_mfma_f32_16x16x32_bf16 v[68:71], v[108:111], v[40:43], v[68:71]
    v_mfma_f32_16x16x32_bf16 v[72:75], v[104:107], v[40:43], 0
    ds_read_b128 v[60:63], v12 offset:704
    s_waitcnt lgkmcnt(4)
    v_mfma_f32_16x16x32_bf16 v[64:67], v[116:119], v[44:47], v[64:67]
    v_mfma_f32_16x16x32_bf16 v[68:71], v[112:115], v[44:47], v[68:71]
    v_mfma_f32_16x16x32_bf16 v[72:75], v[108:111], v[44:47], v[72:75]
    v_mfma_f32_16x16x32_bf16 v[76:79], v[104:107], v[44:47], 0
    ds_read_b128 v[32:35], v13 offset:768
    s_waitcnt lgkmcnt(4)
    v_mfma_f32_16x16x32_bf16 v[64:67], v[120:123], v[48:51], v[64:67]
    v_mfma_f32_16x16x32_bf16 v[68:71], v[116:119], v[48:51], v[68:71]
    v_mfma_f32_16x16x32_bf16 v[72:75], v[112:115], v[48:51], v[72:75]
    v_mfma_f32_16x16x32_bf16 v[76:79], v[108:111], v[48:51], v[76:79]
    ds_read_b128 v[36:39], v12 offset:848
    s_waitcnt lgkmcnt(4)
    v_mfma_f32_16x16x32_bf16 v[64:67], v[124:127], v[52:55], v[64:67]
    v_mfma_f32_16x16x32_bf16 v[68:71], v[120:123], v[52:55], v[68:71]
    v_mfma_f32_16x16x32_bf16 v[72:75], v[116:119], v[52:55], v[72:75]
    v_mfma_f32_16x16x32_bf16 v[76:79], v[112:115], v[52:55], v[76:79]
    ds_read_b128 v[40:43], v12 offset:912
    s_waitcnt lgkmcnt(4)
    v_mfma_f32_16x16x32_bf16 v[64:67], v[128:131], v[56:59], v[64:67]
    v_mfma_f32_16x16x32_bf16 v[68:71], v[124:127], v[56:59], v[68:71]
    v_mfma_f32_16x16x32_bf16 v[72:75], v[120:123], v[56:59], v[72:75]
    v_mfma_f32_16x16x32_bf16 v[76:79], v[116:119], v[56:59], v[76:79]
    ds_read_b128 v[44:47], v12 offset:976
    s_waitcnt lgkmcnt(4)
    v_mfma_f32_16x16x32_bf16 v[64:67], v[132:135], v[60:63], v[64:67]
    v_mfma_f32_16x16x32_bf16 v[68:71], v[128:131], v[60:63], v[68:71]
    v_mfma_f32_16x16x32_bf16 v[72:75], v[124:127], v[60:63], v[72:75]
    v_mfma_f32_16x16x32_bf16 v[76:79], v[120:123], v[60:63], v[76:79]
    s_waitcnt lgkmcnt(3)
    v_mfma_f32_16x16x32_bf16 v[64:67], v[136:139], v[32:35], v[64:67]
    v_mfma_f32_16x16x32_bf16 v[68:71], v[132:135], v[32:35], v[68:71]
    v_mfma_f32_16x16x32_bf16 v[72:75], v[128:131], v[32:35], v[72:75]
    v_mfma_f32_16x16x32_bf16 v[76:79], v[124:127], v[32:35], v[76:79]
    s_waitcnt lgkmcnt(2)
    v_mfma_f32_16x16x32_bf16 v[68:71], v[136:139], v[36:39], v[68:71]
    v_mfma_f32_16x16x32_bf16 v[72:75], v[132:135], v[36:39], v[72:75]
    v_mfma_f32_16x16x32_bf16 v[76:79], v[128:131], v[36:39], v[76:79]
    s_waitcnt lgkmcnt(1)
    v_mfma_f32_16x16x32_bf16 v[72:75], v[136:139], v[40:43], v[72:75]
    v_mfma_f32_16x16x32_bf16 v[76:79], v[132:135], v[40:43], v[76:79]
    s_waitcnt lgkmcnt(0)
    v_mfma_f32_16x16x32_bf16 v[76:79], v[136:139], v[44:47], v[76:79]
    v_mul_u32_u24 v12, 528, v3
    v_lshl_add_u32 v12, v4, 4, v12
    s_lshl_b32 s7, s4, 6
    v_add_u32 v12, s7, v12
    ds_write_b128 v12, v[64:67] offset:26960
    ds_write_b128 v12, v[68:71] offset:27088
    ds_write_b128 v12, v[72:75] offset:27216
    s_nop 0
    ds_write_b128 v12, v[76:79] offset:27344
    s_branch k12c_epi
k12c_seg1:
    v_mul_u32_u24 v12, 112, v9
    v_add_u32 v12, v12, v10
    v_lshlrev_b32 v12, 3, v12
    s_barrier
    ds_read_b64_tr_b16 v[32:33], v12 offset:5840
    ds_read_b64_tr_b16 v[34:35], v12 offset:5872
    ds_read_b64_tr_b16 v[36:37], v12 offset:10080
    ds_read_b64_tr_b16 v[38:39], v12 offset:10112
    ds_read_b64_tr_b16 v[40:41], v12 offset:5968
    ds_read_b64_tr_b16 v[42:43], v12 offset:6000
    ds_read_b64_tr_b16 v[44:45], v12 offset:10208
    ds_read_b64_tr_b16 v[46:47], v12 offset:10240
    ds_read_b64_tr_b16 v[48:49], v12 offset:6096
    ds_read_b64_tr_b16 v[50:51], v12 offset:6128
    s_waitcnt lgkmcnt(8)
    v_mfma_f32_16x16x32_bf16 v[64:67], v[32:35], v[104:107], 0
    ds_read_b64_tr_b16 v[52:53], v12 offset:10336
    ds_read_b64_tr_b16 v[54:55], v12 offset:10368
    s_waitcnt lgkmcnt(8)
    v_mfma_f32_16x16x32_bf16 v[64:67], v[36:39], v[116:119], v[64:67]
    ds_read_b64_tr_b16 v[56:57], v12 offset:6224
    ds_read_b64_tr_b16 v[58:59], v12 offset:6256
    s_waitcnt lgkmcnt(8)
    v_mfma_f32_16x16x32_bf16 v[68:71], v[40:43], v[104:107], 0
    ds_read_b64_tr_b16 v[60:61], v12 offset:10464
    ds_read_b64_tr_b16 v[62:63], v12 offset:10496
    s_waitcnt lgkmcnt(8)
    v_mfma_f32_16x16x32_bf16 v[68:71], v[44:47], v[116:119], v[68:71]
    ds_read_b64_tr_b16 v[32:33], v12 offset:6352
    ds_read_b64_tr_b16 v[34:35], v12 offset:6384
    s_waitcnt lgkmcnt(8)
    v_mfma_f32_16x16x32_bf16 v[72:75], v[48:51], v[104:107], 0
    v_mfma_f32_16x16x32_bf16 v[64:67], v[48:51], v[108:111], v[64:67]
    ds_read_b64_tr_b16 v[36:37], v12 offset:10592
    ds_read_b64_tr_b16 v[38:39], v12 offset:10624
    s_waitcnt lgkmcnt(8)
    v_mfma_f32_16x16x32_bf16 v[72:75], v[52:55], v[116:119], v[72:75]
    v_mfma_f32_16x16x32_bf16 v[64:67], v[52:55], v[120:123], v[64:67]
    ds_read_b64_tr_b16 v[40:41], v12 offset:6480
    ds_read_b64_tr_b16 v[42:43], v12 offset:6512
    s_waitcnt lgkmcnt(8)
    v_mfma_f32_16x16x32_bf16 v[76:79], v[56:59], v[104:107], 0
    v_mfma_f32_16x16x32_bf16 v[68:71], v[56:59], v[108:111], v[68:71]
    ds_read_b64_tr_b16 v[44:45], v12 offset:10720
    ds_read_b64_tr_b16 v[46:47], v12 offset:10752
    s_waitcnt lgkmcnt(8)
    v_mfma_f32_16x16x32_bf16 v[76:79], v[60:63], v[116:119], v[76:79]
    v_mfma_f32_16x16x32_bf16 v[68:71], v[60:63], v[120:123], v[68:71]
    ds_read_b64_tr_b16 v[48:49], v12 offset:6608
    ds_read_b64_tr_b16 v[50:51], v12 offset:6640
    s_waitcnt lgkmcnt(8)
    v_mfma_f32_16x16x32_bf16 v[80:83], v[32:35], v[104:107], 0
    v_mfma_f32_16x16x32_bf16 v[72:75], v[32:35], v[108:111], v[72:75]
    v_mfma_f32_16x16x32_bf16 v[64:67], v[32:35], v[112:115], v[64:67]
    ds_read_b64_tr_b16 v[52:53], v12 offset:10848
    ds_read_b64_tr_b16 v[54:55], v12 offset:10880
    s_waitcnt lgkmcnt(8)
    v_mfma_f32_16x16x32_bf16 v[80:83], v[36:39], v[116:119], v[80:83]
    v_mfma_f32_16x16x32_bf16 v[72:75], v[36:39], v[120:123], v[72:75]
    v_mfma_f32_16x16x32_bf16 v[64:67], v[36:39], v[124:127], v[64:67]
    ds_read_b64_tr_b16 v[56:57], v12 offset:6736
    ds_read_b64_tr_b16 v[58:59], v12 offset:6768
    s_waitcnt lgkmcnt(8)
    v_mfma_f32_16x16x32_bf16 v[84:87], v[40:43], v[104:107], 0
    v_mfma_f32_16x16x32_bf16 v[76:79], v[40:43], v[108:111], v[76:79]
    v_mfma_f32_16x16x32_bf16 v[68:71], v[40:43], v[112:115], v[68:71]
    ds_read_b64_tr_b16 v[60:61], v12 offset:10976
    ds_read_b64_tr_b16 v[62:63], v12 offset:11008
    s_waitcnt lgkmcnt(8)
    v_mfma_f32_16x16x32_bf16 v[84:87], v[44:47], v[116:119], v[84:87]
    v_mfma_f32_16x16x32_bf16 v[76:79], v[44:47], v[120:123], v[76:79]
    v_mfma_f32_16x16x32_bf16 v[68:71], v[44:47], v[124:127], v[68:71]
    ds_read_b64_tr_b16 v[32:33], v12 offset:6864
    ds_read_b64_tr_b16 v[34:35], v12 offset:6896
    s_waitcnt lgkmcnt(8)
    v_mfma_f32_16x16x32_bf16 v[88:91], v[48:51], v[104:107], 0
    v_mfma_f32_16x16x32_bf16 v[80:83], v[48:51], v[108:111], v[80:83]
    v_mfma_f32_16x16x32_bf16 v[72:75], v[48:51], v[112:115], v[72:75]
    ds_read_b64_tr_b16 v[36:37], v12 offset:11104
    ds_read_b64_tr_b16 v[38:39], v12 offset:11136
    s_waitcnt lgkmcnt(8)
    v_mfma_f32_16x16x32_bf16 v[88:91], v[52:55], v[116:119], v[88:91]
    v_mfma_f32_16x16x32_bf16 v[80:83], v[52:55], v[120:123], v[80:83]
    v_mfma_f32_16x16x32_bf16 v[72:75], v[52:55], v[124:127], v[72:75]
    ds_read_b64_tr_b16 v[40:41], v12 offset:6992
    ds_read_b64_tr_b16 v[42:43], v12 offset:7024
    s_waitcnt lgkmcnt(8)
    v_mfma_f32_16x16x32_bf16 v[84:87], v[56:59], v[108:111], v[84:87]
    v_mfma_f32_16x16x32_bf16 v[76:79], v[56:59], v[112:115], v[76:79]
    ds_read_b64_tr_b16 v[44:45], v12 offset:11232
    ds_read_b64_tr_b16 v[46:47], v12 offset:11264
    s_waitcnt lgkmcnt(8)
    v_mfma_f32_16x16x32_bf16 v[84:87], v[60:63], v[120:123], v[84:87]
    v_mfma_f32_16x16x32_bf16 v[76:79], v[60:63], v[124:127], v[76:79]
    ds_read_b64_tr_b16 v[48:49], v12 offset:7120
    ds_read_b64_tr_b16 v[50:51], v12 offset:7152
    s_waitcnt lgkmcnt(8)
    v_mfma_f32_16x16x32_bf16 v[88:91], v[32:35], v[108:111], v[88:91]
    v_mfma_f32_16x16x32_bf16 v[80:83], v[32:35], v[112:115], v[80:83]
    ds_read_b64_tr_b16 v[52:53], v12 offset:11360
    ds_read_b64_tr_b16 v[54:55], v12 offset:11392
    s_waitcnt lgkmcnt(8)
    v_mfma_f32_16x16x32_bf16 v[88:91], v[36:39], v[120:123], v[88:91]
    v_mfma_f32_16x16x32_bf16 v[80:83], v[36:39], v[124:127], v[80:83]
    s_waitcnt lgkmcnt(6)
    v_mfma_f32_16x16x32_bf16 v[84:87], v[40:43], v[112:115], v[84:87]
    s_waitcnt lgkmcnt(4)
    v_mfma_f32_16x16x32_bf16 v[84:87], v[44:47], v[124:127], v[84:87]
    s_waitcnt lgkmcnt(2)
    v_mfma_f32_16x16x32_bf16 v[88:91], v[48:51], v[112:115], v[88:91]
    s_waitcnt lgkmcnt(0)
    v_mfma_f32_16x16x32_bf16 v[88:91], v[52:55], v[124:127], v[88:91]
    v_mul_u32_u24 v12, 112, v4
    v_add_u32 v12, v12, v3
    v_lshlrev_b32 v12, 4, v12
    ds_write_b128 v12, v[64:67] offset:35408
    ds_write_b128 v12, v[68:71] offset:35664
    ds_write_b128 v12, v[72:75] offset:35920
    ds_write_b128 v12, v[76:79] offset:36176
    ds_write_b128 v12, v[80:83] offset:36432
    ds_write_b128 v12, v[84:87] offset:36688
    ds_write_b128 v12, v[88:91] offset:36944
    s_branch k12c_epi
k12c_seg23:
    v_lshrrev_b32 v12, 1, v9
    v_mul_u32_u24 v12, 96, v12
    v_add_u32 v12, v12, v10
    v_lshlrev_b32 v12, 4, v12
    v_and_b32 v13, 1, v9
    v_lshl_add_u32 v12, v13, 3, v12
    v_lshlrev_b32 v13, 5, v10
    v_lshl_add_u32 v13, v9, 3, v13
    s_barrier
    ds_read_b64_tr_b16 v[32:33], v12 offset:14320
    ds_read_b64_tr_b16 v[34:35], v12 offset:14384
    ds_read_b64_tr_b16 v[36:37], v12 offset:5192
    ds_read_b64_tr_b16 v[38:39], v12 offset:5256
    ds_read_b64_tr_b16 v[40:41], v12 offset:14576
    ds_read_b64_tr_b16 v[42:43], v12 offset:14640
    ds_read_b64_tr_b16 v[44:45], v12 offset:5448
    ds_read_b64_tr_b16 v[46:47], v12 offset:5512
    ds_read_b64_tr_b16 v[48:49], v12 offset:14832
    ds_read_b64_tr_b16 v[50:51], v12 offset:14896
    s_waitcnt lgkmcnt(8)
    v_mfma_f32_16x16x32_bf16 v[64:67], v[32:35], v[104:107], 0
    ds_read_b64_tr_b16 v[52:53], v12 offset:5704
    ds_read_b64_tr_b16 v[54:55], v12 offset:5768
    s_waitcnt lgkmcnt(8)
    v_mfma_f32_16x16x32_bf16 v[64:67], v[36:39], v[116:119], v[64:67]
    ds_read_b64_tr_b16 v[56:57], v12 offset:15088
    ds_read_b64_tr_b16 v[58:59], v12 offset:15152
    s_waitcnt lgkmcnt(8)
    v_mfma_f32_16x16x32_bf16 v[68:71], v[40:43], v[104:107], 0
    ds_read_b64_tr_b16 v[60:61], v12 offset:5960
    ds_read_b64_tr_b16 v[62:63], v12 offset:6024
    s_waitcnt lgkmcnt(8)
    v_mfma_f32_16x16x32_bf16 v[68:71], v[44:47], v[116:119], v[68:71]
    ds_read_b64_tr_b16 v[32:33], v12 offset:15344
    ds_read_b64_tr_b16 v[34:35], v12 offset:15408
    s_waitcnt lgkmcnt(8)
    v_mfma_f32_16x16x32_bf16 v[72:75], v[48:51], v[104:107], 0
    v_mfma_f32_16x16x32_bf16 v[64:67], v[48:51], v[108:111], v[64:67]
    ds_read_b64_tr_b16 v[36:37], v12 offset:6216
    ds_read_b64_tr_b16 v[38:39], v12 offset:6280
    s_waitcnt lgkmcnt(8)
    v_mfma_f32_16x16x32_bf16 v[72:75], v[52:55], v[116:119], v[72:75]
    v_mfma_f32_16x16x32_bf16 v[64:67], v[52:55], v[120:123], v[64:67]
    ds_read_b64_tr_b16 v[40:41], v12 offset:15600
    ds_read_b64_tr_b16 v[42:43], v12 offset:15664
    s_waitcnt lgkmcnt(8)
    v_mfma_f32_16x16x32_bf16 v[76:79], v[56:59], v[104:107], 0
    v_mfma_f32_16x16x32_bf16 v[68:71], v[56:59], v[108:111], v[68:71]
    ds_read_b64_tr_b16 v[44:45], v12 offset:6472
    ds_read_b64_tr_b16 v[46:47], v12 offset:6536
    s_waitcnt lgkmcnt(8)
    v_mfma_f32_16x16x32_bf16 v[76:79], v[60:63], v[116:119], v[76:79]
    v_mfma_f32_16x16x32_bf16 v[68:71], v[60:63], v[120:123], v[68:71]
    ds_read_b64_tr_b16 v[48:49], v12 offset:15856
    ds_read_b64_tr_b16 v[50:51], v12 offset:15920
    s_waitcnt lgkmcnt(8)
    v_mfma_f32_16x16x32_bf16 v[80:83], v[32:35], v[104:107], 0
    v_mfma_f32_16x16x32_bf16 v[72:75], v[32:35], v[108:111], v[72:75]
    v_mfma_f32_16x16x32_bf16 v[64:67], v[32:35], v[112:115], v[64:67]
    ds_read_b64_tr_b16 v[52:53], v12 offset:6728
    ds_read_b64_tr_b16 v[54:55], v12 offset:6792
    s_waitcnt lgkmcnt(8)
    v_mfma_f32_16x16x32_bf16 v[80:83], v[36:39], v[116:119], v[80:83]
    v_mfma_f32_16x16x32_bf16 v[72:75], v[36:39], v[120:123], v[72:75]
    v_mfma_f32_16x16x32_bf16 v[64:67], v[36:39], v[124:127], v[64:67]
    ds_read_b64_tr_b16 v[56:57], v12 offset:16112
    ds_read_b64_tr_b16 v[58:59], v12 offset:16176
    s_waitcnt lgkmcnt(8)
    v_mfma_f32_16x16x32_bf16 v[84:87], v[40:43], v[104:107], 0
    v_mfma_f32_16x16x32_bf16 v[76:79], v[40:43], v[108:111], v[76:79]
    v_mfma_f32_16x16x32_bf16 v[68:71], v[40:43], v[112:115], v[68:71]
    ds_read_b64_tr_b16 v[60:61], v12 offset:6984
    ds_read_b64_tr_b16 v[62:63], v12 offset:7048
    s_waitcnt lgkmcnt(8)
    v_mfma_f32_16x16x32_bf16 v[84:87], v[44:47], v[116:119], v[84:87]
    v_mfma_f32_16x16x32_bf16 v[76:79], v[44:47], v[120:123], v[76:79]
    v_mfma_f32_16x16x32_bf16 v[68:71], v[44:47], v[124:127], v[68:71]
    ds_read_b64_tr_b16 v[32:33], v12 offset:16368
    ds_read_b64_tr_b16 v[34:35], v12 offset:16432
    s_waitcnt lgkmcnt(8)
    v_mfma_f32_16x16x32_bf16 v[80:83], v[48:51], v[108:111], v[80:83]
    v_mfma_f32_16x16x32_bf16 v[72:75], v[48:51], v[112:115], v[72:75]
    ds_read_b64_tr_b16 v[36:37], v12 offset:7240
    ds_read_b64_tr_b16 v[38:39], v12 offset:7304
    s_waitcnt lgkmcnt(8)
    v_mfma_f32_16x16x32_bf16 v[80:83], v[52:55], v[120:123], v[80:83]
    v_mfma_f32_16x16x32_bf16 v[72:75], v[52:55], v[124:127], v[72:75]
    ds_read_b64_tr_b16 v[40:41], v12 offset:16624
    ds_read_b64_tr_b16 v[42:43], v12 offset:16688
    s_waitcnt lgkmcnt(8)
    v_mfma_f32_16x16x32_bf16 v[84:87], v[56:59], v[108:111], v[84:87]
    v_mfma_f32_16x16x32_bf16 v[76:79], v[56:59], v[112:115], v[76:79]
    ds_read_b64_tr_b16 v[44:45], v12 offset:7496
    ds_read_b64_tr_b16 v[46:47], v12 offset:7560
    s_waitcnt lgkmcnt(8)
    v_mfma_f32_16x16x32_bf16 v[84:87], v[60:63], v[120:123], v[84:87]
    v_mfma_f32_16x16x32_bf16 v[76:79], v[60:63], v[124:127], v[76:79]
    s_waitcnt lgkmcnt(6)
    v_mfma_f32_16x16x32_bf16 v[80:83], v[32:35], v[112:115], v[80:83]
    s_waitcnt lgkmcnt(4)
    v_mfma_f32_16x16x32_bf16 v[80:83], v[36:39], v[124:127], v[80:83]
    s_waitcnt lgkmcnt(2)
    v_mfma_f32_16x16x32_bf16 v[84:87], v[40:43], v[112:115], v[84:87]
    s_waitcnt lgkmcnt(0)
    v_mfma_f32_16x16x32_bf16 v[84:87], v[44:47], v[124:127], v[84:87]
    ds_read_b64_tr_b16 v[32:33], v13 offset:21792
    ds_read_b64_tr_b16 v[34:35], v13 offset:21920
    ds_read_b64_tr_b16 v[36:37], v13 offset:18688
    ds_read_b64_tr_b16 v[38:39], v13 offset:18816
    ds_read_b64_tr_b16 v[40:41], v13 offset:22304
    ds_read_b64_tr_b16 v[42:43], v13 offset:22432
    ds_read_b64_tr_b16 v[44:45], v13 offset:19200
    ds_read_b64_tr_b16 v[46:47], v13 offset:19328
    ds_read_b64_tr_b16 v[48:49], v13 offset:22816
    ds_read_b64_tr_b16 v[50:51], v13 offset:22944
    s_waitcnt lgkmcnt(8)
    v_mfma_f32_16x16x32_bf16 v[100:103], v[32:35], v[128:131], 0
    v_mfma_f32_16x16x32_bf16 v[92:95], v[32:35], v[132:135], 0
    ds_read_b64_tr_b16 v[52:53], v13 offset:19712
    ds_read_b64_tr_b16 v[54:55], v13 offset:19840
    s_waitcnt lgkmcnt(8)
    v_mfma_f32_16x16x32_bf16 v[100:103], v[36:39], v[140:143], v[100:103]
    v_mfma_f32_16x16x32_bf16 v[92:95], v[36:39], v[144:147], v[92:95]
    ds_read_b64_tr_b16 v[56:57], v13 offset:23328
    ds_read_b64_tr_b16 v[58:59], v13 offset:23456
    s_waitcnt lgkmcnt(8)
    v_mfma_f32_16x16x32_bf16 v[96:99], v[40:43], v[132:135], 0
    v_mfma_f32_16x16x32_bf16 v[88:91], v[40:43], v[136:139], 0
    ds_read_b64_tr_b16 v[60:61], v13 offset:20224
    ds_read_b64_tr_b16 v[62:63], v13 offset:20352
    s_waitcnt lgkmcnt(8)
    v_mfma_f32_16x16x32_bf16 v[96:99], v[44:47], v[144:147], v[96:99]
    v_mfma_f32_16x16x32_bf16 v[88:91], v[44:47], v[148:151], v[88:91]
    ds_read_b64_tr_b16 v[32:33], v13 offset:23840
    ds_read_b64_tr_b16 v[34:35], v13 offset:23968
    s_waitcnt lgkmcnt(8)
    v_mfma_f32_16x16x32_bf16 v[100:103], v[48:51], v[132:135], v[100:103]
    v_mfma_f32_16x16x32_bf16 v[92:95], v[48:51], v[136:139], v[92:95]
    ds_read_b64_tr_b16 v[36:37], v13 offset:20736
    ds_read_b64_tr_b16 v[38:39], v13 offset:20864
    s_waitcnt lgkmcnt(8)
    v_mfma_f32_16x16x32_bf16 v[100:103], v[52:55], v[144:147], v[100:103]
    v_mfma_f32_16x16x32_bf16 v[92:95], v[52:55], v[148:151], v[92:95]
    s_waitcnt lgkmcnt(6)
    v_mfma_f32_16x16x32_bf16 v[96:99], v[56:59], v[136:139], v[96:99]
    s_waitcnt lgkmcnt(4)
    v_mfma_f32_16x16x32_bf16 v[96:99], v[60:63], v[148:151], v[96:99]
    s_waitcnt lgkmcnt(2)
    v_mfma_f32_16x16x32_bf16 v[100:103], v[32:35], v[136:139], v[100:103]
    s_waitcnt lgkmcnt(0)
    v_mfma_f32_16x16x32_bf16 v[100:103], v[36:39], v[148:151], v[100:103]
    v_lshrrev_b32 v12, 1, v4
    v_mul_u32_u24 v12, 96, v12
    v_add_u32 v12, v12, v3
    v_lshlrev_b32 v12, 5, v12
    v_and_b32 v13, 1, v4
    v_lshl_add_u32 v12, v13, 4, v12
    ds_write_b128 v12, v[64:67] offset:14320
    ds_write_b128 v12, v[68:71] offset:14832
    ds_write_b128 v12, v[72:75] offset:15344
    ds_write_b128 v12, v[76:79] offset:15856
    ds_write_b128 v12, v[80:83] offset:16368
    ds_write_b128 v12, v[84:87] offset:16880
    v_lshlrev_b32 v13, 6, v3
    v_lshl_add_u32 v13, v4, 4, v13
    ds_write_b128 v13, v[88:91] offset:20464
    ds_write_b128 v13, v[92:95] offset:21488
    ds_write_b128 v13, v[96:99] offset:22512
    ds_write_b128 v13, v[100:103] offset:23536
k12c_epi:
    v_lshlrev_b32 v12, 5, v0
    v_lshrrev_b32 v13, 4, v0
    v_lshl_add_u32 v13, v13, 4, v12
    v_add_u32 v13, 26960, v13
    v_add_u32 v14, 34384, v12
    v_cmp_le_u32 vcc, 32, v0
    s_nop 1
    v_cndmask_b32 v14, 0, v14, vcc
    v_add_u32 v15, 12272, v12
    v_cmp_le_u32 vcc, 64, v0
    s_nop 1
    v_cndmask_b32 v15, 0, v15, vcc
    v_add_u32 v16, 16368, v12
    v_cmp_le_u32 vcc, 128, v0
    s_nop 1
    v_cndmask_b32 v16, 0, v16, vcc
    v_add_u32 v17, 22848, v6
    v_cmp_le_u32 vcc, 127, v0
    s_nop 1
    v_cndmask_b32 v17, 0, v17, vcc
    s_waitcnt lgkmcnt(0)
    s_barrier
    ds_read_b128 v[32:35], v13
    ds_read_b128 v[36:39], v13 offset:16
    ds_read_b128 v[40:43], v14
    ds_read_b128 v[44:47], v14 offset:16
    ds_read_b128 v[48:51], v15
    ds_read_b128 v[52:55], v15 offset:16
    ds_read_b128 v[56:59], v16
    ds_read_b128 v[60:63], v16 offset:16
    ds_read_b128 v[64:67], v17
    v_mov_b32 v18, v161
    v_lshlrev_b32 v20, 16, v160
    v_pk_mul_f32 v[80:81], v[24:25], v[20:21] op_sel_hi:[1,0]
    v_pk_mul_f32 v[82:83], v[26:27], v[20:21] op_sel_hi:[1,0]
    v_pk_mul_f32 v[84:85], v[28:29], v[20:21] op_sel_hi:[1,0]
    v_pk_mul_f32 v[86:87], v[30:31], v[20:21] op_sel_hi:[1,0]
    v_cvt_pk_bf16_f32 v88, v80, v81
    v_cvt_pk_bf16_f32 v89, v82, v83
    v_cvt_pk_bf16_f32 v90, v84, v85
    v_cvt_pk_bf16_f32 v91, v86, v87
    v_lshlrev_b32 v80, 16, v88
    v_and_b32 v81, 0xffff0000, v88
    v_lshlrev_b32 v82, 16, v89
    v_and_b32 v83, 0xffff0000, v89
    v_lshlrev_b32 v84, 16, v90
    v_and_b32 v85, 0xffff0000, v90
    v_lshlrev_b32 v86, 16, v91
    v_and_b32 v87, 0xffff0000, v91
    s_waitcnt lgkmcnt(5)
    v_pk_add_f32 v[32:33], v[32:33], v[40:41]
    v_pk_add_f32 v[34:35], v[34:35], v[42:43]
    v_pk_add_f32 v[36:37], v[36:37], v[44:45]
    v_pk_add_f32 v[38:39], v[38:39], v[46:47]
    s_waitcnt lgkmcnt(1)
    v_pk_add_f32 v[48:49], v[48:49], v[56:57]
    v_pk_add_f32 v[50:51], v[50:51], v[58:59]
    v_pk_add_f32 v[52:53], v[52:53], v[60:61]
    v_pk_add_f32 v[54:55], v[54:55], v[62:63]
    s_waitcnt lgkmcnt(0)
    v_lshlrev_b32 v68, 16, v64
    v_and_b32 v69, 0xffff0000, v64
    v_lshlrev_b32 v70, 16, v65
    v_and_b32 v71, 0xffff0000, v65
    v_lshlrev_b32 v72, 16, v66
    v_and_b32 v73, 0xffff0000, v66
    v_lshlrev_b32 v74, 16, v67
    v_and_b32 v75, 0xffff0000, v67
    v_pk_add_f32 v[32:33], v[32:33], v[48:49]
    v_pk_add_f32 v[34:35], v[34:35], v[50:51]
    v_pk_add_f32 v[36:37], v[36:37], v[52:53]
    v_pk_add_f32 v[38:39], v[38:39], v[54:55]
    v_pk_fma_f32 v[32:33], v[68:69], v[18:19], v[32:33] op_sel_hi:[1,0,1]
    v_pk_fma_f32 v[34:35], v[70:71], v[18:19], v[34:35] op_sel_hi:[1,0,1]
    v_pk_fma_f32 v[36:37], v[72:73], v[18:19], v[36:37] op_sel_hi:[1,0,1]
    v_pk_fma_f32 v[38:39], v[74:75], v[18:19], v[38:39] op_sel_hi:[1,0,1]
    v_cvt_pk_bf16_f32 v88, v32, v33
    v_cvt_pk_bf16_f32 v89, v34, v35
    v_cvt_pk_bf16_f32 v90, v36, v37
    v_cvt_pk_bf16_f32 v91, v38, v39
    v_lshlrev_b32 v32, 16, v88
    v_and_b32 v33, 0xffff0000, v88
    v_lshlrev_b32 v34, 16, v89
    v_and_b32 v35, 0xffff0000, v89
    v_lshlrev_b32 v36, 16, v90
    v_and_b32 v37, 0xffff0000, v90
    v_lshlrev_b32 v38, 16, v91
    v_and_b32 v39, 0xffff0000, v91
    v_pk_add_f32 v[32:33], v[32:33], v[80:81]
    v_pk_add_f32 v[34:35], v[34:35], v[82:83]
    v_pk_add_f32 v[36:37], v[36:37], v[84:85]
    v_pk_add_f32 v[38:39], v[38:39], v[86:87]
    v_cvt_pk_bf16_f32 v88, v32, v33
    v_cvt_pk_bf16_f32 v89, v34, v35
    v_cvt_pk_bf16_f32 v90, v36, v37
    v_cvt_pk_bf16_f32 v91, v38, v39
    v_lshlrev_b32 v32, 16, v88
    v_and_b32 v33, 0xffff0000, v88
    v_lshlrev_b32 v34, 16, v89
    v_and_b32 v35, 0xffff0000, v89
    v_lshlrev_b32 v36, 16, v90
    v_and_b32 v37, 0xffff0000, v90
    v_lshlrev_b32 v38, 16, v91
    v_and_b32 v39, 0xffff0000, v91
    v_pk_mul_f32 v[32:33], v[32:33], v[162:163] op_sel_hi:[1,0]
    v_pk_mul_f32 v[34:35], v[34:35], v[162:163] op_sel_hi:[1,0]
    v_pk_mul_f32 v[36:37], v[36:37], v[162:163] op_sel_hi:[1,0]
    v_pk_mul_f32 v[38:39], v[38:39], v[162:163] op_sel_hi:[1,0]
    v_cvt_pk_bf16_f32 v88, v32, v33
    v_cvt_pk_bf16_f32 v89, v34, v35
    v_cvt_pk_bf16_f32 v90, v36, v37
    v_cvt_pk_bf16_f32 v91, v38, v39
    v_lshlrev_b32 v32, 16, v88
    v_and_b32 v33, 0xffff0000, v88
    v_lshlrev_b32 v34, 16, v89
    v_and_b32 v35, 0xffff0000, v89
    v_lshlrev_b32 v36, 16, v90
    v_and_b32 v37, 0xffff0000, v90
    v_lshlrev_b32 v38, 16, v91
    v_and_b32 v39, 0xffff0000, v91
    v_lshlrev_b32 v92, 16, v152
    v_and_b32 v93, 0xffff0000, v152
    v_lshlrev_b32 v94, 16, v153
    v_and_b32 v95, 0xffff0000, v153
    v_lshlrev_b32 v96, 16, v154
    v_and_b32 v97, 0xffff0000, v154
    v_lshlrev_b32 v98, 16, v155
    v_and_b32 v99, 0xffff0000, v155
    v_pk_add_f32 v[32:33], v[32:33], v[92:93]
    v_pk_add_f32 v[34:35], v[34:35], v[94:95]
    v_pk_add_f32 v[36:37], v[36:37], v[96:97]
    v_pk_add_f32 v[38:39], v[38:39], v[98:99]
    v_cvt_pk_bf16_f32 v88, v32, v33
    v_cvt_pk_bf16_f32 v89, v34, v35
    v_cvt_pk_bf16_f32 v90, v36, v37
    v_cvt_pk_bf16_f32 v91, v38, v39
    buffer_store_dwordx4 v[88:91], v6, s[60:63], s9 offen
    s_endpgm
    s_nop 0
k12_ln:
    s_setprio 3
    s_sub_u32 s13, s2, 148
    s_lshl_b32 s5, s13, 5
    s_mov_b32 s48, s16
    s_mov_b32 s49, s17
    s_mov_b32 s50, 0x1c0000
    s_mov_b32 s51, 0x20000
    s_add_u32 s52, s46, 0x10000
    s_addc_u32 s53, s47, 0
    s_mov_b32 s54, 0x2000
    s_mov_b32 s55, 0x20000
    s_add_u32 s56, s46, 0x200000
    s_addc_u32 s57, s47, 0
    s_mov_b32 s58, 0x1c0000
    s_mov_b32 s59, 0x20000
    s_mov_b32 s72, s44
    s_mov_b32 s73, s45
    s_mov_b32 s74, 0x100
    s_mov_b32 s75, 0x20000
    s_lshl_b32 s12, s4, 3
    s_add_u32 s12, s12, s5
    s_mul_i32 s6, s12, 896
    s_add_u32 s7, s6, 3584
    v_lshlrev_b32 v3, 4, v1
    v_mov_b32 v4, 0x7ffffff0
    v_cmp_gt_u32 vcc, 56, v1
    s_nop 1
    v_cndmask_b32 v4, v4, v3, vcc
    buffer_load_dwordx4 v[8:11], v4, s[48:51], s6 offen offset:0
    buffer_load_dwordx4 v[12:15], v4, s[48:51], s6 offen offset:896
    buffer_load_dwordx4 v[16:19], v4, s[48:51], s6 offen offset:1792
    buffer_load_dwordx4 v[20:23], v4, s[48:51], s6 offen offset:2688
    buffer_load_dwordx4 v[24:27], v4, s[48:51], s7 offen offset:0
    buffer_load_dwordx4 v[28:31], v4, s[48:51], s7 offen offset:896
    buffer_load_dwordx4 v[32:35], v4, s[48:51], s7 offen offset:1792
    buffer_load_dwordx4 v[36:39], v4, s[48:51], s7 offen offset:2688
    s_mul_i32 s8, s4, 7296
    v_add_u32 v5, s8, v3
    v_lshrrev_b32 v6, 4, v1
    v_bfe_u32 v7, v1, 2, 2
    v_lshl_add_u32 v7, v6, 3, v7
    v_mul_u32_u24 v7, 912, v7
    v_and_b32 v104, 3, v1
    v_lshl_add_u32 v7, v104, 3, v7
    s_lshl_b32 s9, s4, 5
    v_add_u32 v7, s9, v7
    v_and_b32 v104, 15, v1
    s_lshl_b32 s9, s4, 4
    v_add_u32 v104, s9, v104
    v_lshlrev_b32 v104, 12, v104
    v_lshl_add_u32 v6, v6, 4, v104
    s_lshl_b32 s11, s5, 1
    v_mov_b32 v158, 0x3b124925
    s_mov_b32 exec_hi, 0x00ffffff
    s_waitcnt vmcnt(7)
    ds_write_b128 v5, v[8:11] offset:0
    s_waitcnt vmcnt(6)
    ds_write_b128 v5, v[12:15] offset:912
    s_waitcnt vmcnt(5)
    ds_write_b128 v5, v[16:19] offset:1824
    s_waitcnt vmcnt(4)
    ds_write_b128 v5, v[20:23] offset:2736
    s_waitcnt vmcnt(3)
    ds_write_b128 v5, v[24:27] offset:3648
    s_waitcnt vmcnt(2)
    ds_write_b128 v5, v[28:31] offset:4560
    s_waitcnt vmcnt(1)
    ds_write_b128 v5, v[32:35] offset:5472
    s_waitcnt vmcnt(0)
    ds_write_b128 v5, v[36:39] offset:6384
    s_mov_b32 exec_hi, -1
    s_waitcnt lgkmcnt(0)
    s_barrier
    ds_read_b64_tr_b16 v[104:105], v7 offset:0
    ds_read_b64_tr_b16 v[106:107], v7 offset:3648
    ds_read_b64_tr_b16 v[108:109], v7 offset:128
    ds_read_b64_tr_b16 v[110:111], v7 offset:3776
    ds_read_b64_tr_b16 v[112:113], v7 offset:256
    ds_read_b64_tr_b16 v[114:115], v7 offset:3904
    ds_read_b64_tr_b16 v[116:117], v7 offset:384
    ds_read_b64_tr_b16 v[118:119], v7 offset:4032
    ds_read_b64_tr_b16 v[120:121], v7 offset:512
    ds_read_b64_tr_b16 v[122:123], v7 offset:4160
    ds_read_b64_tr_b16 v[124:125], v7 offset:640
    ds_read_b64_tr_b16 v[126:127], v7 offset:4288
    ds_read_b64_tr_b16 v[128:129], v7 offset:768
    ds_read_b64_tr_b16 v[130:131], v7 offset:4416
    s_waitcnt lgkmcnt(12)
    buffer_store_dwordx4 v[104:107], v6, s[56:59], s11 offen sc1
    s_add_u32 s11, s11, 0x40000
    s_waitcnt lgkmcnt(10)
    buffer_store_dwordx4 v[108:111], v6, s[56:59], s11 offen sc1
    s_add_u32 s11, s11, 0x40000
    s_waitcnt lgkmcnt(8)
    buffer_store_dwordx4 v[112:115], v6, s[56:59], s11 offen sc1
    s_add_u32 s11, s11, 0x40000
    s_waitcnt lgkmcnt(6)
    buffer_store_dwordx4 v[116:119], v6, s[56:59], s11 offen sc1
    s_add_u32 s11, s11, 0x40000
    s_waitcnt lgkmcnt(4)
    buffer_store_dwordx4 v[120:123], v6, s[56:59], s11 offen sc1
    s_add_u32 s11, s11, 0x40000
    s_waitcnt lgkmcnt(2)
    buffer_store_dwordx4 v[124:127], v6, s[56:59], s11 offen sc1
    s_add_u32 s11, s11, 0x40000
    s_waitcnt lgkmcnt(0)
    buffer_store_dwordx4 v[128:131], v6, s[56:59], s11 offen sc1
    s_waitcnt vmcnt(0)
    s_barrier
    s_cmp_lg_u32 s4, 0
    s_cbranch_scc1 sig_lnA
    s_mov_b64 exec, 1
    v_mov_b32 v2, 1
    buffer_atomic_add v2, off, s[72:75], 0 offset:0 sc0 sc1
    s_waitcnt vmcnt(0)
    v_readfirstlane_b32 s79, v2
    s_nop 0
    s_cmp_lg_u32 s79, 63
    s_nop 2
    s_cbranch_scc1 sig_lnA_x
    v_mov_b32 v2, 1
    buffer_store_dword v2, off, s[72:75], 0 offset:128 sc1
    s_nop 0
sig_lnA_x:
    s_mov_b64 exec, -1
sig_lnA:
    s_setprio 0
    s_mov_b32 s5, s13
    s_branch k12_wprep
k12_st:
    s_setprio 3
    s_sub_u32 s13, s2, 84
    s_lshl_b32 s5, s13, 5
    s_mov_b32 s48, s16
    s_mov_b32 s49, s17
    s_mov_b32 s50, 0x1c0000
    s_mov_b32 s51, 0x20000
    s_add_u32 s52, s46, 0x10000
    s_addc_u32 s53, s47, 0
    s_mov_b32 s54, 0x2000
    s_mov_b32 s55, 0x20000
    s_mov_b32 s72, s44
    s_mov_b32 s73, s45
    s_mov_b32 s74, 0x100
    s_mov_b32 s75, 0x20000
    s_lshl_b32 s12, s4, 3
    s_add_u32 s12, s12, s5
    s_mul_i32 s6, s12, 896
    s_add_u32 s7, s6, 3584
    v_lshlrev_b32 v3, 4, v1
    v_mov_b32 v4, 0x7ffffff0
    v_cmp_gt_u32 vcc, 56, v1
    s_nop 1
    v_cndmask_b32 v4, v4, v3, vcc
    buffer_load_dwordx4 v[8:11], v4, s[48:51], s6 offen offset:0
    buffer_load_dwordx4 v[12:15], v4, s[48:51], s6 offen offset:896
    buffer_load_dwordx4 v[16:19], v4, s[48:51], s6 offen offset:1792
    buffer_load_dwordx4 v[20:23], v4, s[48:51], s6 offen offset:2688
    buffer_load_dwordx4 v[24:27], v4, s[48:51], s7 offen offset:0
    buffer_load_dwordx4 v[28:31], v4, s[48:51], s7 offen offset:896
    buffer_load_dwordx4 v[32:35], v4, s[48:51], s7 offen offset:1792
    buffer_load_dwordx4 v[36:39], v4, s[48:51], s7 offen offset:2688
    v_mov_b32 v158, 0x3b124925
    s_waitcnt vmcnt(0)
    v_lshlrev_b32 v40, 16, v8
    v_and_b32 v41, 0xffff0000, v8
    v_lshlrev_b32 v42, 16, v9
    v_and_b32 v43, 0xffff0000, v9
    v_lshlrev_b32 v44, 16, v10
    v_and_b32 v45, 0xffff0000, v10
    v_lshlrev_b32 v46, 16, v11
    v_and_b32 v47, 0xffff0000, v11
    v_lshlrev_b32 v48, 16, v12
    v_and_b32 v49, 0xffff0000, v12
    v_lshlrev_b32 v50, 16, v13
    v_and_b32 v51, 0xffff0000, v13
    v_lshlrev_b32 v52, 16, v14
    v_and_b32 v53, 0xffff0000, v14
    v_lshlrev_b32 v54, 16, v15
    v_and_b32 v55, 0xffff0000, v15
    v_lshlrev_b32 v56, 16, v16
    v_and_b32 v57, 0xffff0000, v16
    v_lshlrev_b32 v58, 16, v17
    v_and_b32 v59, 0xffff0000, v17
    v_lshlrev_b32 v60, 16, v18
    v_and_b32 v61, 0xffff0000, v18
    v_lshlrev_b32 v62, 16, v19
    v_and_b32 v63, 0xffff0000, v19
    v_lshlrev_b32 v64, 16, v20
    v_and_b32 v65, 0xffff0000, v20
    v_lshlrev_b32 v66, 16, v21
    v_and_b32 v67, 0xffff0000, v21
    v_lshlrev_b32 v68, 16, v22
    v_and_b32 v69, 0xffff0000, v22
    v_lshlrev_b32 v70, 16, v23
    v_and_b32 v71, 0xffff0000, v23
    v_lshlrev_b32 v72, 16, v24
    v_and_b32 v73, 0xffff0000, v24
    v_lshlrev_b32 v74, 16, v25
    v_and_b32 v75, 0xffff0000, v25
    v_lshlrev_b32 v76, 16, v26
    v_and_b32 v77, 0xffff0000, v26
    v_lshlrev_b32 v78, 16, v27
    v_and_b32 v79, 0xffff0000, v27
    v_lshlrev_b32 v80, 16, v28
    v_and_b32 v81, 0xffff0000, v28
    v_lshlrev_b32 v82, 16, v29
    v_and_b32 v83, 0xffff0000, v29
    v_lshlrev_b32 v84, 16, v30
    v_and_b32 v85, 0xffff0000, v30
    v_lshlrev_b32 v86, 16, v31
    v_and_b32 v87, 0xffff0000, v31
    v_lshlrev_b32 v88, 16, v32
    v_and_b32 v89, 0xffff0000, v32
    v_lshlrev_b32 v90, 16, v33
    v_and_b32 v91, 0xffff0000, v33
    v_lshlrev_b32 v92, 16, v34
    v_and_b32 v93, 0xffff0000, v34
    v_lshlrev_b32 v94, 16, v35
    v_and_b32 v95, 0xffff0000, v35
    v_lshlrev_b32 v96, 16, v36
    v_and_b32 v97, 0xffff0000, v36
    v_lshlrev_b32 v98, 16, v37
    v_and_b32 v99, 0xffff0000, v37
    v_lshlrev_b32 v100, 16, v38
    v_and_b32 v101, 0xffff0000, v38
    v_lshlrev_b32 v102, 16, v39
    v_and_b32 v103, 0xffff0000, v39
    v_pk_add_f32 v[132:133], v[40:41], v[42:43]
    v_pk_add_f32 v[16:17], v[44:45], v[46:47]
    v_pk_add_f32 v[134:135], v[48:49], v[50:51]
    v_pk_add_f32 v[18:19], v[52:53], v[54:55]
    v_pk_add_f32 v[136:137], v[56:57], v[58:59]
    v_pk_add_f32 v[20:21], v[60:61], v[62:63]
    v_pk_add_f32 v[138:139], v[64:65], v[66:67]
    v_pk_add_f32 v[22:23], v[68:69], v[70:71]
    v_pk_add_f32 v[140:141], v[72:73], v[74:75]
    v_pk_add_f32 v[24:25], v[76:77], v[78:79]
    v_pk_add_f32 v[142:143], v[80:81], v[82:83]
    v_pk_add_f32 v[26:27], v[84:85], v[86:87]
    v_pk_add_f32 v[144:145], v[88:89], v[90:91]
    v_pk_add_f32 v[28:29], v[92:93], v[94:95]
    v_pk_add_f32 v[146:147], v[96:97], v[98:99]
    v_pk_add_f32 v[30:31], v[100:101], v[102:103]
    v_pk_add_f32 v[132:133], v[132:133], v[16:17]
    v_pk_add_f32 v[134:135], v[134:135], v[18:19]
    v_pk_add_f32 v[136:137], v[136:137], v[20:21]
    v_pk_add_f32 v[138:139], v[138:139], v[22:23]
    v_pk_add_f32 v[140:141], v[140:141], v[24:25]
    v_pk_add_f32 v[142:143], v[142:143], v[26:27]
    v_pk_add_f32 v[144:145], v[144:145], v[28:29]
    v_pk_add_f32 v[146:147], v[146:147], v[30:31]
    v_add_f32 v8, v132, v133
    v_add_f32 v9, v134, v135
    v_add_f32 v10, v136, v137
    v_add_f32 v11, v138, v139
    v_add_f32 v12, v140, v141
    v_add_f32 v13, v142, v143
    v_add_f32 v14, v144, v145
    v_add_f32 v15, v146, v147
    v_add_f32_dpp v8, v8, v8 row_shr:1 row_mask:0xf bank_mask:0xf bound_ctrl:0
    v_add_f32_dpp v9, v9, v9 row_shr:1 row_mask:0xf bank_mask:0xf bound_ctrl:0
    v_add_f32_dpp v10, v10, v10 row_shr:1 row_mask:0xf bank_mask:0xf bound_ctrl:0
    v_add_f32_dpp v11, v11, v11 row_shr:1 row_mask:0xf bank_mask:0xf bound_ctrl:0
    v_add_f32_dpp v12, v12, v12 row_shr:1 row_mask:0xf bank_mask:0xf bound_ctrl:0
    v_add_f32_dpp v13, v13, v13 row_shr:1 row_mask:0xf bank_mask:0xf bound_ctrl:0
    v_add_f32_dpp v14, v14, v14 row_shr:1 row_mask:0xf bank_mask:0xf bound_ctrl:0
    v_add_f32_dpp v15, v15, v15 row_shr:1 row_mask:0xf bank_mask:0xf bound_ctrl:0
    v_add_f32_dpp v8, v8, v8 row_shr:2 row_mask:0xf bank_mask:0xf bound_ctrl:0
    v_add_f32_dpp v9, v9, v9 row_shr:2 row_mask:0xf bank_mask:0xf bound_ctrl:0
    v_add_f32_dpp v10, v10, v10 row_shr:2 row_mask:0xf bank_mask:0xf bound_ctrl:0
    v_add_f32_dpp v11, v11, v11 row_shr:2 row_mask:0xf bank_mask:0xf bound_ctrl:0
    v_add_f32_dpp v12, v12, v12 row_shr:2 row_mask:0xf bank_mask:0xf bound_ctrl:0
    v_add_f32_dpp v13, v13, v13 row_shr:2 row_mask:0xf bank_mask:0xf bound_ctrl:0
    v_add_f32_dpp v14, v14, v14 row_shr:2 row_mask:0xf bank_mask:0xf bound_ctrl:0
    v_add_f32_dpp v15, v15, v15 row_shr:2 row_mask:0xf bank_mask:0xf bound_ctrl:0
    v_add_f32_dpp v8, v8, v8 row_shr:4 row_mask:0xf bank_mask:0xf bound_ctrl:0
    v_add_f32_dpp v9, v9, v9 row_shr:4 row_mask:0xf bank_mask:0xf bound_ctrl:0
    v_add_f32_dpp v10, v10, v10 row_shr:4 row_mask:0xf bank_mask:0xf bound_ctrl:0
    v_add_f32_dpp v11, v11, v11 row_shr:4 row_mask:0xf bank_mask:0xf bound_ctrl:0
    v_add_f32_dpp v12, v12, v12 row_shr:4 row_mask:0xf bank_mask:0xf bound_ctrl:0
    v_add_f32_dpp v13, v13, v13 row_shr:4 row_mask:0xf bank_mask:0xf bound_ctrl:0
    v_add_f32_dpp v14, v14, v14 row_shr:4 row_mask:0xf bank_mask:0xf bound_ctrl:0
    v_add_f32_dpp v15, v15, v15 row_shr:4 row_mask:0xf bank_mask:0xf bound_ctrl:0
    v_add_f32_dpp v8, v8, v8 row_shr:8 row_mask:0xf bank_mask:0xf bound_ctrl:0
    v_add_f32_dpp v9, v9, v9 row_shr:8 row_mask:0xf bank_mask:0xf bound_ctrl:0
    v_add_f32_dpp v10, v10, v10 row_shr:8 row_mask:0xf bank_mask:0xf bound_ctrl:0
    v_add_f32_dpp v11, v11, v11 row_shr:8 row_mask:0xf bank_mask:0xf bound_ctrl:0
    v_add_f32_dpp v12, v12, v12 row_shr:8 row_mask:0xf bank_mask:0xf bound_ctrl:0
    v_add_f32_dpp v13, v13, v13 row_shr:8 row_mask:0xf bank_mask:0xf bound_ctrl:0
    v_add_f32_dpp v14, v14, v14 row_shr:8 row_mask:0xf bank_mask:0xf bound_ctrl:0
    v_add_f32_dpp v15, v15, v15 row_shr:8 row_mask:0xf bank_mask:0xf bound_ctrl:0
    v_add_f32_dpp v8, v8, v8 row_bcast:15 row_mask:0xa bank_mask:0xf
    v_add_f32_dpp v9, v9, v9 row_bcast:15 row_mask:0xa bank_mask:0xf
    v_add_f32_dpp v10, v10, v10 row_bcast:15 row_mask:0xa bank_mask:0xf
    v_add_f32_dpp v11, v11, v11 row_bcast:15 row_mask:0xa bank_mask:0xf
    v_add_f32_dpp v12, v12, v12 row_bcast:15 row_mask:0xa bank_mask:0xf
    v_add_f32_dpp v13, v13, v13 row_bcast:15 row_mask:0xa bank_mask:0xf
    v_add_f32_dpp v14, v14, v14 row_bcast:15 row_mask:0xa bank_mask:0xf
    v_add_f32_dpp v15, v15, v15 row_bcast:15 row_mask:0xa bank_mask:0xf
    v_add_f32_dpp v8, v8, v8 row_bcast:31 row_mask:0xc bank_mask:0xf
    v_add_f32_dpp v9, v9, v9 row_bcast:31 row_mask:0xc bank_mask:0xf
    v_add_f32_dpp v10, v10, v10 row_bcast:31 row_mask:0xc bank_mask:0xf
    v_add_f32_dpp v11, v11, v11 row_bcast:31 row_mask:0xc bank_mask:0xf
    v_add_f32_dpp v12, v12, v12 row_bcast:31 row_mask:0xc bank_mask:0xf
    v_add_f32_dpp v13, v13, v13 row_bcast:31 row_mask:0xc bank_mask:0xf
    v_add_f32_dpp v14, v14, v14 row_bcast:31 row_mask:0xc bank_mask:0xf
    v_add_f32_dpp v15, v15, v15 row_bcast:31 row_mask:0xc bank_mask:0xf
    v_readlane_b32 s60, v8, 63
    v_readlane_b32 s61, v9, 63
    v_readlane_b32 s62, v10, 63
    v_readlane_b32 s63, v11, 63
    v_readlane_b32 s64, v12, 63
    v_readlane_b32 s65, v13, 63
    v_readlane_b32 s66, v14, 63
    v_readlane_b32 s67, v15, 63
    v_mul_f32 v132, s60, v158
    v_mul_f32 v134, s61, v158
    v_mul_f32 v136, s62, v158
    v_mul_f32 v138, s63, v158
    v_mul_f32 v140, s64, v158
    v_mul_f32 v142, s65, v158
    v_mul_f32 v144, s66, v158
    v_mul_f32 v146, s67, v158
    v_pk_add_f32 v[40:41], v[40:41], v[132:133] op_sel_hi:[1,0] neg_lo:[0,1] neg_hi:[0,1]
    v_pk_add_f32 v[42:43], v[42:43], v[132:133] op_sel_hi:[1,0] neg_lo:[0,1] neg_hi:[0,1]
    v_pk_add_f32 v[44:45], v[44:45], v[132:133] op_sel_hi:[1,0] neg_lo:[0,1] neg_hi:[0,1]
    v_pk_add_f32 v[46:47], v[46:47], v[132:133] op_sel_hi:[1,0] neg_lo:[0,1] neg_hi:[0,1]
    v_pk_add_f32 v[48:49], v[48:49], v[134:135] op_sel_hi:[1,0] neg_lo:[0,1] neg_hi:[0,1]
    v_pk_add_f32 v[50:51], v[50:51], v[134:135] op_sel_hi:[1,0] neg_lo:[0,1] neg_hi:[0,1]
    v_pk_add_f32 v[52:53], v[52:53], v[134:135] op_sel_hi:[1,0] neg_lo:[0,1] neg_hi:[0,1]
    v_pk_add_f32 v[54:55], v[54:55], v[134:135] op_sel_hi:[1,0] neg_lo:[0,1] neg_hi:[0,1]
    v_pk_add_f32 v[56:57], v[56:57], v[136:137] op_sel_hi:[1,0] neg_lo:[0,1] neg_hi:[0,1]
    v_pk_add_f32 v[58:59], v[58:59], v[136:137] op_sel_hi:[1,0] neg_lo:[0,1] neg_hi:[0,1]
    v_pk_add_f32 v[60:61], v[60:61], v[136:137] op_sel_hi:[1,0] neg_lo:[0,1] neg_hi:[0,1]
    v_pk_add_f32 v[62:63], v[62:63], v[136:137] op_sel_hi:[1,0] neg_lo:[0,1] neg_hi:[0,1]
    v_pk_add_f32 v[64:65], v[64:65], v[138:139] op_sel_hi:[1,0] neg_lo:[0,1] neg_hi:[0,1]
    v_pk_add_f32 v[66:67], v[66:67], v[138:139] op_sel_hi:[1,0] neg_lo:[0,1] neg_hi:[0,1]
    v_pk_add_f32 v[68:69], v[68:69], v[138:139] op_sel_hi:[1,0] neg_lo:[0,1] neg_hi:[0,1]
    v_pk_add_f32 v[70:71], v[70:71], v[138:139] op_sel_hi:[1,0] neg_lo:[0,1] neg_hi:[0,1]
    v_pk_add_f32 v[72:73], v[72:73], v[140:141] op_sel_hi:[1,0] neg_lo:[0,1] neg_hi:[0,1]
    v_pk_add_f32 v[74:75], v[74:75], v[140:141] op_sel_hi:[1,0] neg_lo:[0,1] neg_hi:[0,1]
    v_pk_add_f32 v[76:77], v[76:77], v[140:141] op_sel_hi:[1,0] neg_lo:[0,1] neg_hi:[0,1]
    v_pk_add_f32 v[78:79], v[78:79], v[140:141] op_sel_hi:[1,0] neg_lo:[0,1] neg_hi:[0,1]
    v_pk_add_f32 v[80:81], v[80:81], v[142:143] op_sel_hi:[1,0] neg_lo:[0,1] neg_hi:[0,1]
    v_pk_add_f32 v[82:83], v[82:83], v[142:143] op_sel_hi:[1,0] neg_lo:[0,1] neg_hi:[0,1]
    v_pk_add_f32 v[84:85], v[84:85], v[142:143] op_sel_hi:[1,0] neg_lo:[0,1] neg_hi:[0,1]
    v_pk_add_f32 v[86:87], v[86:87], v[142:143] op_sel_hi:[1,0] neg_lo:[0,1] neg_hi:[0,1]
    v_pk_add_f32 v[88:89], v[88:89], v[144:145] op_sel_hi:[1,0] neg_lo:[0,1] neg_hi:[0,1]
    v_pk_add_f32 v[90:91], v[90:91], v[144:145] op_sel_hi:[1,0] neg_lo:[0,1] neg_hi:[0,1]
    v_pk_add_f32 v[92:93], v[92:93], v[144:145] op_sel_hi:[1,0] neg_lo:[0,1] neg_hi:[0,1]
    v_pk_add_f32 v[94:95], v[94:95], v[144:145] op_sel_hi:[1,0] neg_lo:[0,1] neg_hi:[0,1]
    v_pk_add_f32 v[96:97], v[96:97], v[146:147] op_sel_hi:[1,0] neg_lo:[0,1] neg_hi:[0,1]
    v_pk_add_f32 v[98:99], v[98:99], v[146:147] op_sel_hi:[1,0] neg_lo:[0,1] neg_hi:[0,1]
    v_pk_add_f32 v[100:101], v[100:101], v[146:147] op_sel_hi:[1,0] neg_lo:[0,1] neg_hi:[0,1]
    v_pk_add_f32 v[102:103], v[102:103], v[146:147] op_sel_hi:[1,0] neg_lo:[0,1] neg_hi:[0,1]
    v_pk_mul_f32 v[16:17], v[40:41], v[40:41]
    v_pk_mul_f32 v[18:19], v[48:49], v[48:49]
    v_pk_mul_f32 v[20:21], v[56:57], v[56:57]
    v_pk_mul_f32 v[22:23], v[64:65], v[64:65]
    v_pk_mul_f32 v[24:25], v[72:73], v[72:73]
    v_pk_mul_f32 v[26:27], v[80:81], v[80:81]
    v_pk_mul_f32 v[28:29], v[88:89], v[88:89]
    v_pk_mul_f32 v[30:31], v[96:97], v[96:97]
    v_pk_fma_f32 v[16:17], v[42:43], v[42:43], v[16:17]
    v_pk_fma_f32 v[18:19], v[50:51], v[50:51], v[18:19]
    v_pk_fma_f32 v[20:21], v[58:59], v[58:59], v[20:21]
    v_pk_fma_f32 v[22:23], v[66:67], v[66:67], v[22:23]
    v_pk_fma_f32 v[24:25], v[74:75], v[74:75], v[24:25]
    v_pk_fma_f32 v[26:27], v[82:83], v[82:83], v[26:27]
    v_pk_fma_f32 v[28:29], v[90:91], v[90:91], v[28:29]
    v_pk_fma_f32 v[30:31], v[98:99], v[98:99], v[30:31]
    v_pk_fma_f32 v[16:17], v[44:45], v[44:45], v[16:17]
    v_pk_fma_f32 v[18:19], v[52:53], v[52:53], v[18:19]
    v_pk_fma_f32 v[20:21], v[60:61], v[60:61], v[20:21]
    v_pk_fma_f32 v[22:23], v[68:69], v[68:69], v[22:23]
    v_pk_fma_f32 v[24:25], v[76:77], v[76:77], v[24:25]
    v_pk_fma_f32 v[26:27], v[84:85], v[84:85], v[26:27]
    v_pk_fma_f32 v[28:29], v[92:93], v[92:93], v[28:29]
    v_pk_fma_f32 v[30:31], v[100:101], v[100:101], v[30:31]
    v_pk_fma_f32 v[16:17], v[46:47], v[46:47], v[16:17]
    v_pk_fma_f32 v[18:19], v[54:55], v[54:55], v[18:19]
    v_pk_fma_f32 v[20:21], v[62:63], v[62:63], v[20:21]
    v_pk_fma_f32 v[22:23], v[70:71], v[70:71], v[22:23]
    v_pk_fma_f32 v[24:25], v[78:79], v[78:79], v[24:25]
    v_pk_fma_f32 v[26:27], v[86:87], v[86:87], v[26:27]
    v_pk_fma_f32 v[28:29], v[94:95], v[94:95], v[28:29]
    v_pk_fma_f32 v[30:31], v[102:103], v[102:103], v[30:31]
    v_add_f32 v8, v16, v17
    v_add_f32 v9, v18, v19
    v_add_f32 v10, v20, v21
    v_add_f32 v11, v22, v23
    v_add_f32 v12, v24, v25
    v_add_f32 v13, v26, v27
    v_add_f32 v14, v28, v29
    v_add_f32 v15, v30, v31
    v_cndmask_b32 v8, 0, v8, vcc
    v_cndmask_b32 v9, 0, v9, vcc
    v_cndmask_b32 v10, 0, v10, vcc
    v_cndmask_b32 v11, 0, v11, vcc
    v_cndmask_b32 v12, 0, v12, vcc
    v_cndmask_b32 v13, 0, v13, vcc
    v_cndmask_b32 v14, 0, v14, vcc
    v_cndmask_b32 v15, 0, v15, vcc
    v_add_f32_dpp v8, v8, v8 row_shr:1 row_mask:0xf bank_mask:0xf bound_ctrl:0
    v_add_f32_dpp v9, v9, v9 row_shr:1 row_mask:0xf bank_mask:0xf bound_ctrl:0
    v_add_f32_dpp v10, v10, v10 row_shr:1 row_mask:0xf bank_mask:0xf bound_ctrl:0
    v_add_f32_dpp v11, v11, v11 row_shr:1 row_mask:0xf bank_mask:0xf bound_ctrl:0
    v_add_f32_dpp v12, v12, v12 row_shr:1 row_mask:0xf bank_mask:0xf bound_ctrl:0
    v_add_f32_dpp v13, v13, v13 row_shr:1 row_mask:0xf bank_mask:0xf bound_ctrl:0
    v_add_f32_dpp v14, v14, v14 row_shr:1 row_mask:0xf bank_mask:0xf bound_ctrl:0
    v_add_f32_dpp v15, v15, v15 row_shr:1 row_mask:0xf bank_mask:0xf bound_ctrl:0
    v_add_f32_dpp v8, v8, v8 row_shr:2 row_mask:0xf bank_mask:0xf bound_ctrl:0
    v_add_f32_dpp v9, v9, v9 row_shr:2 row_mask:0xf bank_mask:0xf bound_ctrl:0
    v_add_f32_dpp v10, v10, v10 row_shr:2 row_mask:0xf bank_mask:0xf bound_ctrl:0
    v_add_f32_dpp v11, v11, v11 row_shr:2 row_mask:0xf bank_mask:0xf bound_ctrl:0
    v_add_f32_dpp v12, v12, v12 row_shr:2 row_mask:0xf bank_mask:0xf bound_ctrl:0
    v_add_f32_dpp v13, v13, v13 row_shr:2 row_mask:0xf bank_mask:0xf bound_ctrl:0
    v_add_f32_dpp v14, v14, v14 row_shr:2 row_mask:0xf bank_mask:0xf bound_ctrl:0
    v_add_f32_dpp v15, v15, v15 row_shr:2 row_mask:0xf bank_mask:0xf bound_ctrl:0
    v_add_f32_dpp v8, v8, v8 row_shr:4 row_mask:0xf bank_mask:0xf bound_ctrl:0
    v_add_f32_dpp v9, v9, v9 row_shr:4 row_mask:0xf bank_mask:0xf bound_ctrl:0
    v_add_f32_dpp v10, v10, v10 row_shr:4 row_mask:0xf bank_mask:0xf bound_ctrl:0
    v_add_f32_dpp v11, v11, v11 row_shr:4 row_mask:0xf bank_mask:0xf bound_ctrl:0
    v_add_f32_dpp v12, v12, v12 row_shr:4 row_mask:0xf bank_mask:0xf bound_ctrl:0
    v_add_f32_dpp v13, v13, v13 row_shr:4 row_mask:0xf bank_mask:0xf bound_ctrl:0
    v_add_f32_dpp v14, v14, v14 row_shr:4 row_mask:0xf bank_mask:0xf bound_ctrl:0
    v_add_f32_dpp v15, v15, v15 row_shr:4 row_mask:0xf bank_mask:0xf bound_ctrl:0
    v_add_f32_dpp v8, v8, v8 row_shr:8 row_mask:0xf bank_mask:0xf bound_ctrl:0
    v_add_f32_dpp v9, v9, v9 row_shr:8 row_mask:0xf bank_mask:0xf bound_ctrl:0
    v_add_f32_dpp v10, v10, v10 row_shr:8 row_mask:0xf bank_mask:0xf bound_ctrl:0
    v_add_f32_dpp v11, v11, v11 row_shr:8 row_mask:0xf bank_mask:0xf bound_ctrl:0
    v_add_f32_dpp v12, v12, v12 row_shr:8 row_mask:0xf bank_mask:0xf bound_ctrl:0
    v_add_f32_dpp v13, v13, v13 row_shr:8 row_mask:0xf bank_mask:0xf bound_ctrl:0
    v_add_f32_dpp v14, v14, v14 row_shr:8 row_mask:0xf bank_mask:0xf bound_ctrl:0
    v_add_f32_dpp v15, v15, v15 row_shr:8 row_mask:0xf bank_mask:0xf bound_ctrl:0
    v_add_f32_dpp v8, v8, v8 row_bcast:15 row_mask:0xa bank_mask:0xf
    v_add_f32_dpp v9, v9, v9 row_bcast:15 row_mask:0xa bank_mask:0xf
    v_add_f32_dpp v10, v10, v10 row_bcast:15 row_mask:0xa bank_mask:0xf
    v_add_f32_dpp v11, v11, v11 row_bcast:15 row_mask:0xa bank_mask:0xf
    v_add_f32_dpp v12, v12, v12 row_bcast:15 row_mask:0xa bank_mask:0xf
    v_add_f32_dpp v13, v13, v13 row_bcast:15 row_mask:0xa bank_mask:0xf
    v_add_f32_dpp v14, v14, v14 row_bcast:15 row_mask:0xa bank_mask:0xf
    v_add_f32_dpp v15, v15, v15 row_bcast:15 row_mask:0xa bank_mask:0xf
    v_add_f32_dpp v8, v8, v8 row_bcast:31 row_mask:0xc bank_mask:0xf
    v_add_f32_dpp v9, v9, v9 row_bcast:31 row_mask:0xc bank_mask:0xf
    v_add_f32_dpp v10, v10, v10 row_bcast:31 row_mask:0xc bank_mask:0xf
    v_add_f32_dpp v11, v11, v11 row_bcast:31 row_mask:0xc bank_mask:0xf
    v_add_f32_dpp v12, v12, v12 row_bcast:31 row_mask:0xc bank_mask:0xf
    v_add_f32_dpp v13, v13, v13 row_bcast:31 row_mask:0xc bank_mask:0xf
    v_add_f32_dpp v14, v14, v14 row_bcast:31 row_mask:0xc bank_mask:0xf
    v_add_f32_dpp v15, v15, v15 row_bcast:31 row_mask:0xc bank_mask:0xf
    v_readlane_b32 s60, v8, 63
    v_readlane_b32 s61, v9, 63
    v_readlane_b32 s62, v10, 63
    v_readlane_b32 s63, v11, 63
    v_readlane_b32 s64, v12, 63
    v_readlane_b32 s65, v13, 63
    v_readlane_b32 s66, v14, 63
    v_readlane_b32 s67, v15, 63
    v_mul_f32 v133, s60, v158
    v_mul_f32 v135, s61, v158
    v_mul_f32 v137, s62, v158
    v_mul_f32 v139, s63, v158
    v_mul_f32 v141, s64, v158
    v_mul_f32 v143, s65, v158
    v_mul_f32 v145, s66, v158
    v_mul_f32 v147, s67, v158
    v_cvt_pk_bf16_f32 v132, v132, v132
    v_lshlrev_b32 v132, 16, v132
    v_cvt_pk_bf16_f32 v133, v133, v133
    v_lshlrev_b32 v133, 16, v133
    v_cvt_pk_bf16_f32 v134, v134, v134
    v_lshlrev_b32 v134, 16, v134
    v_cvt_pk_bf16_f32 v135, v135, v135
    v_lshlrev_b32 v135, 16, v135
    v_cvt_pk_bf16_f32 v136, v136, v136
    v_lshlrev_b32 v136, 16, v136
    v_cvt_pk_bf16_f32 v137, v137, v137
    v_lshlrev_b32 v137, 16, v137
    v_cvt_pk_bf16_f32 v138, v138, v138
    v_lshlrev_b32 v138, 16, v138
    v_cvt_pk_bf16_f32 v139, v139, v139
    v_lshlrev_b32 v139, 16, v139
    v_cvt_pk_bf16_f32 v140, v140, v140
    v_lshlrev_b32 v140, 16, v140
    v_cvt_pk_bf16_f32 v141, v141, v141
    v_lshlrev_b32 v141, 16, v141
    v_cvt_pk_bf16_f32 v142, v142, v142
    v_lshlrev_b32 v142, 16, v142
    v_cvt_pk_bf16_f32 v143, v143, v143
    v_lshlrev_b32 v143, 16, v143
    v_cvt_pk_bf16_f32 v144, v144, v144
    v_lshlrev_b32 v144, 16, v144
    v_cvt_pk_bf16_f32 v145, v145, v145
    v_lshlrev_b32 v145, 16, v145
    v_cvt_pk_bf16_f32 v146, v146, v146
    v_lshlrev_b32 v146, 16, v146
    v_cvt_pk_bf16_f32 v147, v147, v147
    v_lshlrev_b32 v147, 16, v147
    v_add_f32 v133, 0x3727c5ac, v133
    v_add_f32 v135, 0x3727c5ac, v135
    v_add_f32 v137, 0x3727c5ac, v137
    v_add_f32 v139, 0x3727c5ac, v139
    v_add_f32 v141, 0x3727c5ac, v141
    v_add_f32 v143, 0x3727c5ac, v143
    v_add_f32 v145, 0x3727c5ac, v145
    v_add_f32 v147, 0x3727c5ac, v147
    v_cvt_pk_bf16_f32 v133, v133, v133
    v_lshlrev_b32 v133, 16, v133
    v_cvt_pk_bf16_f32 v135, v135, v135
    v_lshlrev_b32 v135, 16, v135
    v_cvt_pk_bf16_f32 v137, v137, v137
    v_lshlrev_b32 v137, 16, v137
    v_cvt_pk_bf16_f32 v139, v139, v139
    v_lshlrev_b32 v139, 16, v139
    v_cvt_pk_bf16_f32 v141, v141, v141
    v_lshlrev_b32 v141, 16, v141
    v_cvt_pk_bf16_f32 v143, v143, v143
    v_lshlrev_b32 v143, 16, v143
    v_cvt_pk_bf16_f32 v145, v145, v145
    v_lshlrev_b32 v145, 16, v145
    v_cvt_pk_bf16_f32 v147, v147, v147
    v_lshlrev_b32 v147, 16, v147
    v_sqrt_f32 v133, v133
    v_sqrt_f32 v135, v135
    v_sqrt_f32 v137, v137
    v_sqrt_f32 v139, v139
    v_sqrt_f32 v141, v141
    v_sqrt_f32 v143, v143
    v_sqrt_f32 v145, v145
    v_sqrt_f32 v147, v147
    v_cvt_pk_bf16_f32 v133, v133, v133
    v_lshlrev_b32 v133, 16, v133
    v_cvt_pk_bf16_f32 v135, v135, v135
    v_lshlrev_b32 v135, 16, v135
    v_cvt_pk_bf16_f32 v137, v137, v137
    v_lshlrev_b32 v137, 16, v137
    v_cvt_pk_bf16_f32 v139, v139, v139
    v_lshlrev_b32 v139, 16, v139
    v_cvt_pk_bf16_f32 v141, v141, v141
    v_lshlrev_b32 v141, 16, v141
    v_cvt_pk_bf16_f32 v143, v143, v143
    v_lshlrev_b32 v143, 16, v143
    v_cvt_pk_bf16_f32 v145, v145, v145
    v_lshlrev_b32 v145, 16, v145
    v_cvt_pk_bf16_f32 v147, v147, v147
    v_lshlrev_b32 v147, 16, v147
    v_cvt_pk_bf16_f32 v16, v132, v133
    v_cvt_pk_bf16_f32 v17, v134, v135
    v_cvt_pk_bf16_f32 v18, v136, v137
    v_cvt_pk_bf16_f32 v19, v138, v139
    v_cvt_pk_bf16_f32 v20, v140, v141
    v_cvt_pk_bf16_f32 v21, v142, v143
    v_cvt_pk_bf16_f32 v22, v144, v145
    v_cvt_pk_bf16_f32 v23, v146, v147
    s_lshl_b32 s7, s12, 2
    s_mov_b64 exec, 1
    buffer_store_dwordx4 v[16:19], off, s[52:55], s7 offset:0 sc1
    buffer_store_dwordx4 v[20:23], off, s[52:55], s7 offset:16 sc1
    s_mov_b64 exec, -1
    s_waitcnt vmcnt(0)
    s_barrier
    s_cmp_lg_u32 s4, 0
    s_cbranch_scc1 sig_stA
    s_mov_b64 exec, 1
    v_mov_b32 v2, 1
    buffer_atomic_add v2, off, s[72:75], 0 offset:32 sc0 sc1
    s_waitcnt vmcnt(0)
    v_readfirstlane_b32 s79, v2
    s_nop 0
    s_cmp_lg_u32 s79, 63
    s_nop 2
    s_cbranch_scc1 sig_stA_x
    v_mov_b32 v2, 1
    buffer_store_dword v2, off, s[72:75], 0 offset:132 sc1
    s_nop 0
sig_stA_x:
    s_mov_b64 exec, -1
sig_stA:
    s_setprio 0
    s_add_u32 s5, s13, 120
    s_branch k12_wprep
k12_mod:
    s_setprio 3
    s_sub_u32 s5, s2, 0
    s_mov_b32 s48, s40
    s_mov_b32 s49, s41
    s_mov_b32 s50, 0x24c000
    s_mov_b32 s51, 0x20000
    s_mov_b32 s52, s38
    s_mov_b32 s53, s39
    s_mov_b32 s54, 0x380
    s_mov_b32 s55, 0x20000
    s_mov_b32 s56, s46
    s_mov_b32 s57, s47
    s_mov_b32 s58, 0x2a00
    s_mov_b32 s59, 0x20000
    s_mov_b32 s72, s44
    s_mov_b32 s73, s45
    s_mov_b32 s74, 0x100
    s_mov_b32 s75, 0x20000
    v_lshrrev_b32 v3, 2, v0
    v_and_b32 v4, 3, v0
    s_mov_b32 s6, 37632
    v_mul_lo_u32 v5, v3, s6
    v_lshl_add_u32 v5, v4, 4, v5
    s_lshl_b32 s7, s5, 6
    v_mul_u32_u24 v6, 14, v3
    buffer_load_ushort v8, v6, s[52:55], 0 offen offset:0
    buffer_load_ushort v9, v6, s[52:55], 0 offen offset:2
    buffer_load_ushort v10, v6, s[52:55], 0 offen offset:4
    buffer_load_ushort v11, v6, s[52:55], 0 offen offset:6
    buffer_load_ushort v12, v6, s[52:55], 0 offen offset:8
    buffer_load_ushort v13, v6, s[52:55], 0 offen offset:10
    buffer_load_ushort v14, v6, s[52:55], 0 offen offset:12
    buffer_load_dwordx4 v[16:19], v5, s[48:51], s7 offen
    s_add_u32 s7, s7, 5376
    buffer_load_dwordx4 v[20:23], v5, s[48:51], s7 offen
    s_add_u32 s7, s7, 5376
    buffer_load_dwordx4 v[24:27], v5, s[48:51], s7 offen
    s_add_u32 s7, s7, 5376
    buffer_load_dwordx4 v[28:31], v5, s[48:51], s7 offen
    s_add_u32 s7, s7, 5376
    buffer_load_dwordx4 v[32:35], v5, s[48:51], s7 offen
    s_add_u32 s7, s7, 5376
    buffer_load_dwordx4 v[36:39], v5, s[48:51], s7 offen
    s_add_u32 s7, s7, 5376
    buffer_load_dwordx4 v[40:43], v5, s[48:51], s7 offen
    s_waitcnt vmcnt(7)
    v_lshlrev_b32 v72, 16, v8
    v_lshlrev_b32 v74, 16, v9
    v_lshlrev_b32 v76, 16, v10
    v_lshlrev_b32 v78, 16, v11
    v_lshlrev_b32 v80, 16, v12
    v_lshlrev_b32 v82, 16, v13
    v_lshlrev_b32 v84, 16, v14
    v_mul_f32 v73, 0xbfb8aa3b, v72
    v_mul_f32 v75, 0xbfb8aa3b, v74
    v_mul_f32 v77, 0xbfb8aa3b, v76
    v_mul_f32 v79, 0xbfb8aa3b, v78
    v_mul_f32 v81, 0xbfb8aa3b, v80
    v_mul_f32 v83, 0xbfb8aa3b, v82
    v_mul_f32 v85, 0xbfb8aa3b, v84
    v_exp_f32 v73, v73
    v_exp_f32 v75, v75
    v_exp_f32 v77, v77
    v_exp_f32 v79, v79
    v_exp_f32 v81, v81
    v_exp_f32 v83, v83
    v_exp_f32 v85, v85
    v_add_f32 v73, 1.0, v73
    v_add_f32 v75, 1.0, v75
    v_add_f32 v77, 1.0, v77
    v_add_f32 v79, 1.0, v79
    v_add_f32 v81, 1.0, v81
    v_add_f32 v83, 1.0, v83
    v_add_f32 v85, 1.0, v85
    v_rcp_f32 v112, v73
    v_rcp_f32 v113, v75
    v_rcp_f32 v114, v77
    v_rcp_f32 v115, v79
    v_rcp_f32 v116, v81
    v_rcp_f32 v117, v83
    v_rcp_f32 v118, v85
    v_mul_f32 v128, v72, v112
    v_mul_f32 v129, v74, v113
    v_mul_f32 v130, v76, v114
    v_mul_f32 v131, v78, v115
    v_mul_f32 v132, v80, v116
    v_mul_f32 v133, v82, v117
    v_mul_f32 v134, v84, v118
    v_fma_f32 v72, -v128, v73, v72
    v_fma_f32 v74, -v129, v75, v74
    v_fma_f32 v76, -v130, v77, v76
    v_fma_f32 v78, -v131, v79, v78
    v_fma_f32 v80, -v132, v81, v80
    v_fma_f32 v82, -v133, v83, v82
    v_fma_f32 v84, -v134, v85, v84
    v_fma_f32 v72, v72, v112, v128
    v_fma_f32 v74, v74, v113, v129
    v_fma_f32 v76, v76, v114, v130
    v_fma_f32 v78, v78, v115, v131
    v_fma_f32 v80, v80, v116, v132
    v_fma_f32 v82, v82, v117, v133
    v_fma_f32 v84, v84, v118, v134
    v_cvt_pk_bf16_f32 v72, v72, v72
    v_lshlrev_b32 v72, 16, v72
    v_cvt_pk_bf16_f32 v74, v74, v74
    v_lshlrev_b32 v74, 16, v74
    v_cvt_pk_bf16_f32 v76, v76, v76
    v_lshlrev_b32 v76, 16, v76
    v_cvt_pk_bf16_f32 v78, v78, v78
    v_lshlrev_b32 v78, 16, v78
    v_cvt_pk_bf16_f32 v80, v80, v80
    v_lshlrev_b32 v80, 16, v80
    v_cvt_pk_bf16_f32 v82, v82, v82
    v_lshlrev_b32 v82, 16, v82
    v_cvt_pk_bf16_f32 v84, v84, v84
    v_lshlrev_b32 v84, 16, v84
    s_waitcnt vmcnt(6)
    v_lshlrev_b32 v112, 16, v16
    v_and_b32 v113, 0xffff0000, v16
    v_lshlrev_b32 v114, 16, v17
    v_and_b32 v115, 0xffff0000, v17
    v_lshlrev_b32 v116, 16, v18
    v_and_b32 v117, 0xffff0000, v18
    v_lshlrev_b32 v118, 16, v19
    v_and_b32 v119, 0xffff0000, v19
    v_pk_mul_f32 v[104:105], v[112:113], v[72:73] op_sel_hi:[1,0]
    v_pk_mul_f32 v[106:107], v[114:115], v[72:73] op_sel_hi:[1,0]
    v_pk_mul_f32 v[108:109], v[116:117], v[72:73] op_sel_hi:[1,0]
    v_pk_mul_f32 v[110:111], v[118:119], v[72:73] op_sel_hi:[1,0]
    s_waitcnt vmcnt(5)
    v_lshlrev_b32 v112, 16, v20
    v_and_b32 v113, 0xffff0000, v20
    v_lshlrev_b32 v114, 16, v21
    v_and_b32 v115, 0xffff0000, v21
    v_lshlrev_b32 v116, 16, v22
    v_and_b32 v117, 0xffff0000, v22
    v_lshlrev_b32 v118, 16, v23
    v_and_b32 v119, 0xffff0000, v23
    v_pk_fma_f32 v[104:105], v[112:113], v[74:75], v[104:105] op_sel_hi:[1,0,1]
    v_pk_fma_f32 v[106:107], v[114:115], v[74:75], v[106:107] op_sel_hi:[1,0,1]
    v_pk_fma_f32 v[108:109], v[116:117], v[74:75], v[108:109] op_sel_hi:[1,0,1]
    v_pk_fma_f32 v[110:111], v[118:119], v[74:75], v[110:111] op_sel_hi:[1,0,1]
    s_waitcnt vmcnt(4)
    v_lshlrev_b32 v112, 16, v24
    v_and_b32 v113, 0xffff0000, v24
    v_lshlrev_b32 v114, 16, v25
    v_and_b32 v115, 0xffff0000, v25
    v_lshlrev_b32 v116, 16, v26
    v_and_b32 v117, 0xffff0000, v26
    v_lshlrev_b32 v118, 16, v27
    v_and_b32 v119, 0xffff0000, v27
    v_pk_fma_f32 v[104:105], v[112:113], v[76:77], v[104:105] op_sel_hi:[1,0,1]
    v_pk_fma_f32 v[106:107], v[114:115], v[76:77], v[106:107] op_sel_hi:[1,0,1]
    v_pk_fma_f32 v[108:109], v[116:117], v[76:77], v[108:109] op_sel_hi:[1,0,1]
    v_pk_fma_f32 v[110:111], v[118:119], v[76:77], v[110:111] op_sel_hi:[1,0,1]
    s_waitcnt vmcnt(3)
    v_lshlrev_b32 v112, 16, v28
    v_and_b32 v113, 0xffff0000, v28
    v_lshlrev_b32 v114, 16, v29
    v_and_b32 v115, 0xffff0000, v29
    v_lshlrev_b32 v116, 16, v30
    v_and_b32 v117, 0xffff0000, v30
    v_lshlrev_b32 v118, 16, v31
    v_and_b32 v119, 0xffff0000, v31
    v_pk_fma_f32 v[104:105], v[112:113], v[78:79], v[104:105] op_sel_hi:[1,0,1]
    v_pk_fma_f32 v[106:107], v[114:115], v[78:79], v[106:107] op_sel_hi:[1,0,1]
    v_pk_fma_f32 v[108:109], v[116:117], v[78:79], v[108:109] op_sel_hi:[1,0,1]
    v_pk_fma_f32 v[110:111], v[118:119], v[78:79], v[110:111] op_sel_hi:[1,0,1]
    s_waitcnt vmcnt(2)
    v_lshlrev_b32 v112, 16, v32
    v_and_b32 v113, 0xffff0000, v32
    v_lshlrev_b32 v114, 16, v33
    v_and_b32 v115, 0xffff0000, v33
    v_lshlrev_b32 v116, 16, v34
    v_and_b32 v117, 0xffff0000, v34
    v_lshlrev_b32 v118, 16, v35
    v_and_b32 v119, 0xffff0000, v35
    v_pk_fma_f32 v[104:105], v[112:113], v[80:81], v[104:105] op_sel_hi:[1,0,1]
    v_pk_fma_f32 v[106:107], v[114:115], v[80:81], v[106:107] op_sel_hi:[1,0,1]
    v_pk_fma_f32 v[108:109], v[116:117], v[80:81], v[108:109] op_sel_hi:[1,0,1]
    v_pk_fma_f32 v[110:111], v[118:119], v[80:81], v[110:111] op_sel_hi:[1,0,1]
    s_waitcnt vmcnt(1)
    v_lshlrev_b32 v112, 16, v36
    v_and_b32 v113, 0xffff0000, v36
    v_lshlrev_b32 v114, 16, v37
    v_and_b32 v115, 0xffff0000, v37
    v_lshlrev_b32 v116, 16, v38
    v_and_b32 v117, 0xffff0000, v38
    v_lshlrev_b32 v118, 16, v39
    v_and_b32 v119, 0xffff0000, v39
    v_pk_fma_f32 v[104:105], v[112:113], v[82:83], v[104:105] op_sel_hi:[1,0,1]
    v_pk_fma_f32 v[106:107], v[114:115], v[82:83], v[106:107] op_sel_hi:[1,0,1]
    v_pk_fma_f32 v[108:109], v[116:117], v[82:83], v[108:109] op_sel_hi:[1,0,1]
    v_pk_fma_f32 v[110:111], v[118:119], v[82:83], v[110:111] op_sel_hi:[1,0,1]
    s_waitcnt vmcnt(0)
    v_lshlrev_b32 v112, 16, v40
    v_and_b32 v113, 0xffff0000, v40
    v_lshlrev_b32 v114, 16, v41
    v_and_b32 v115, 0xffff0000, v41
    v_lshlrev_b32 v116, 16, v42
    v_and_b32 v117, 0xffff0000, v42
    v_lshlrev_b32 v118, 16, v43
    v_and_b32 v119, 0xffff0000, v43
    v_pk_fma_f32 v[104:105], v[112:113], v[84:85], v[104:105] op_sel_hi:[1,0,1]
    v_pk_fma_f32 v[106:107], v[114:115], v[84:85], v[106:107] op_sel_hi:[1,0,1]
    v_pk_fma_f32 v[108:109], v[116:117], v[84:85], v[108:109] op_sel_hi:[1,0,1]
    v_pk_fma_f32 v[110:111], v[118:119], v[84:85], v[110:111] op_sel_hi:[1,0,1]
    v_add_f32_dpp v104, v104, v104 row_shr:4 row_mask:0xf bank_mask:0xf bound_ctrl:0
    v_add_f32_dpp v105, v105, v105 row_shr:4 row_mask:0xf bank_mask:0xf bound_ctrl:0
    v_add_f32_dpp v106, v106, v106 row_shr:4 row_mask:0xf bank_mask:0xf bound_ctrl:0
    v_add_f32_dpp v107, v107, v107 row_shr:4 row_mask:0xf bank_mask:0xf bound_ctrl:0
    v_add_f32_dpp v108, v108, v108 row_shr:4 row_mask:0xf bank_mask:0xf bound_ctrl:0
    v_add_f32_dpp v109, v109, v109 row_shr:4 row_mask:0xf bank_mask:0xf bound_ctrl:0
    v_add_f32_dpp v110, v110, v110 row_shr:4 row_mask:0xf bank_mask:0xf bound_ctrl:0
    v_add_f32_dpp v111, v111, v111 row_shr:4 row_mask:0xf bank_mask:0xf bound_ctrl:0
    v_add_f32_dpp v104, v104, v104 row_shr:8 row_mask:0xf bank_mask:0xf bound_ctrl:0
    v_add_f32_dpp v105, v105, v105 row_shr:8 row_mask:0xf bank_mask:0xf bound_ctrl:0
    v_add_f32_dpp v106, v106, v106 row_shr:8 row_mask:0xf bank_mask:0xf bound_ctrl:0
    v_add_f32_dpp v107, v107, v107 row_shr:8 row_mask:0xf bank_mask:0xf bound_ctrl:0
    v_add_f32_dpp v108, v108, v108 row_shr:8 row_mask:0xf bank_mask:0xf bound_ctrl:0
    v_add_f32_dpp v109, v109, v109 row_shr:8 row_mask:0xf bank_mask:0xf bound_ctrl:0
    v_add_f32_dpp v110, v110, v110 row_shr:8 row_mask:0xf bank_mask:0xf bound_ctrl:0
    v_add_f32_dpp v111, v111, v111 row_shr:8 row_mask:0xf bank_mask:0xf bound_ctrl:0
    v_lshrrev_b32 v8, 4, v0
    v_lshl_add_u32 v8, v8, 2, v4
    v_lshlrev_b32 v8, 5, v8
    s_mov_b32 exec_lo, 0xf000f000
    s_mov_b32 exec_hi, 0xf000f000
    ds_write_b128 v8, v[104:107] offset:0
    ds_write_b128 v8, v[108:111] offset:16
    s_mov_b64 exec, -1
    s_waitcnt lgkmcnt(0)
    s_barrier
    s_cmp_lg_u32 s4, 0
    s_cbranch_scc1 k12_mod_sig
    v_and_b32 v9, 31, v1
    v_lshlrev_b32 v10, 2, v9
    v_lshrrev_b32 v11, 5, v1
    v_lshl_add_u32 v11, v11, 10, v10
    ds_read_b32 v16, v11 offset:0
    ds_read_b32 v17, v11 offset:128
    ds_read_b32 v18, v11 offset:256
    ds_read_b32 v19, v11 offset:384
    ds_read_b32 v20, v11 offset:512
    ds_read_b32 v21, v11 offset:640
    ds_read_b32 v22, v11 offset:768
    ds_read_b32 v23, v11 offset:896
    s_lshl_b32 s7, s5, 7
    s_waitcnt lgkmcnt(0)
    v_add_f32 v16, v16, v20
    v_add_f32 v17, v17, v21
    v_add_f32 v18, v18, v22
    v_add_f32 v19, v19, v23
    v_add_f32 v16, v16, v18
    v_add_f32 v17, v17, v19
    v_add_f32 v16, v16, v17
    v_mov_b32 v17, v16
    s_nop 1
    v_permlane32_swap_b32 v16, v17
    v_add_f32 v16, v16, v17
    v_cvt_pk_bf16_f32 v8, v16, v16
    v_lshlrev_b32 v8, 16, v8
    s_mov_b32 exec_hi, 0
    buffer_store_dword v8, v10, s[56:59], s7 offen sc1
    s_mov_b64 exec, -1
k12_mod_sig:
    s_cmp_ge_u32 s5, 70
    s_cbranch_scc1 k12_mod_wp
    s_cmp_ge_u32 s5, 42
    s_cbranch_scc1 k12_mod_sig2
    s_waitcnt vmcnt(0)
    s_barrier
    s_cmp_lg_u32 s4, 0
    s_cbranch_scc1 sig_mod
    s_mov_b64 exec, 1
    v_mov_b32 v2, 1
    buffer_atomic_add v2, off, s[72:75], 0 offset:64 sc0 sc1
    s_waitcnt vmcnt(0)
    v_readfirstlane_b32 s79, v2
    s_nop 0
    s_cmp_lg_u32 s79, 41
    s_nop 2
    s_cbranch_scc1 sig_mod_x
    v_mov_b32 v2, 1
    buffer_store_dword v2, off, s[72:75], 0 offset:136 sc1
    s_nop 0
sig_mod_x:
    s_mov_b64 exec, -1
sig_mod:
    s_endpgm
k12_mod_sig2:
    s_waitcnt vmcnt(0)
    s_barrier
    s_cmp_lg_u32 s4, 0
    s_cbranch_scc1 sig_mod2
    s_mov_b64 exec, 1
    v_mov_b32 v2, 1
    buffer_atomic_add v2, off, s[72:75], 0 offset:96 sc0 sc1
    s_waitcnt vmcnt(0)
    v_readfirstlane_b32 s79, v2
    s_nop 0
    s_cmp_lg_u32 s79, 27
    s_nop 2
    s_cbranch_scc1 sig_mod2_x
    v_mov_b32 v2, 1
    buffer_store_dword v2, off, s[72:75], 0 offset:140 sc1
    s_nop 0
sig_mod2_x:
    s_mov_b64 exec, -1
sig_mod2:
    s_cmp_lt_u32 s5, 44
    s_cbranch_scc1 k12_kernel_done
k12_mod_wp:
    s_setprio 0
    s_add_u32 s5, s5, 140
    s_branch k12_wprep
k12_w2:
    s_sub_u32 s5, s2, 212
    s_mov_b32 s48, s36
    s_mov_b32 s49, s37
    s_mov_b32 s50, 0x188000
    s_mov_b32 s51, 0x20000
    s_add_u32 s52, s46, 0xb00000
    s_addc_u32 s53, s47, 0
    s_mov_b32 s54, 0x188000
    s_mov_b32 s55, 0x20000
    s_mov_b32 s72, s44
    s_mov_b32 s73, s45
    s_mov_b32 s74, 0x100
    s_mov_b32 s75, 0x20000
    v_lshlrev_b32 v3, 4, v1
    s_cmp_lg_u32 s5, 0
    s_nop 0
    s_cbranch_scc1 k12_w2_nz
    s_add_u32 s56, s46, 0x8000
    s_addc_u32 s57, s47, 0
    s_mov_b32 s58, 0x1000
    s_mov_b32 s59, 0x20000
    v_mov_b32 v8, 0
    v_mov_b32 v9, 0
    v_mov_b32 v10, 0
    v_mov_b32 v11, 0
    v_lshlrev_b32 v4, 4, v0
    buffer_store_dwordx4 v[8:11], v4, s[56:59], 0 offen
    s_nop 1
k12_w2_nz:
    s_mul_i32 s6, s5, 28672
    s_lshl_b32 s7, s4, 10
    s_add_u32 s6, s6, s7
    s_mov_b32 m0, s7
    s_nop 0
    buffer_load_dwordx4 v3, s[48:51], s6 offen lds
    s_add_u32 s6, s6, 4096
    s_add_u32 s7, s7, 4096
    s_mov_b32 m0, s7
    s_nop 0
    buffer_load_dwordx4 v3, s[48:51], s6 offen lds
    s_add_u32 s6, s6, 4096
    s_add_u32 s7, s7, 4096
    s_mov_b32 m0, s7
    s_nop 0
    buffer_load_dwordx4 v3, s[48:51], s6 offen lds
    s_add_u32 s6, s6, 4096
    s_add_u32 s7, s7, 4096
    s_mov_b32 m0, s7
    s_nop 0
    buffer_load_dwordx4 v3, s[48:51], s6 offen lds
    s_add_u32 s6, s6, 4096
    s_add_u32 s7, s7, 4096
    s_mov_b32 m0, s7
    s_nop 0
    buffer_load_dwordx4 v3, s[48:51], s6 offen lds
    s_add_u32 s6, s6, 4096
    s_add_u32 s7, s7, 4096
    s_mov_b32 m0, s7
    s_nop 0
    buffer_load_dwordx4 v3, s[48:51], s6 offen lds
    s_add_u32 s6, s6, 4096
    s_add_u32 s7, s7, 4096
    s_mov_b32 m0, s7
    s_nop 0
    buffer_load_dwordx4 v3, s[48:51], s6 offen lds
    v_lshrrev_b32 v4, 4, v1
    v_bfe_u32 v5, v1, 2, 2
    v_lshl_add_u32 v4, v4, 3, v5
    v_mul_u32_u24 v4, 896, v4
    v_and_b32 v5, 3, v1
    v_lshl_add_u32 v4, v5, 5, v4
    s_lshl_b32 s8, s4, 3
    v_add_u32 v4, s8, v4
    s_lshl_b32 s9, s5, 2
    s_add_u32 s9, s9, s4
    s_lshl_b32 s9, s9, 10
    s_waitcnt vmcnt(0)
    s_barrier
    ds_read_b64_tr_b16 v[8:9], v4 offset:0
    ds_read_b64_tr_b16 v[10:11], v4 offset:3584
    ds_read_b64_tr_b16 v[12:13], v4 offset:128
    ds_read_b64_tr_b16 v[14:15], v4 offset:3712
    ds_read_b64_tr_b16 v[16:17], v4 offset:256
    ds_read_b64_tr_b16 v[18:19], v4 offset:3840
    ds_read_b64_tr_b16 v[20:21], v4 offset:384
    ds_read_b64_tr_b16 v[22:23], v4 offset:3968
    ds_read_b64_tr_b16 v[24:25], v4 offset:512
    ds_read_b64_tr_b16 v[26:27], v4 offset:4096
    ds_read_b64_tr_b16 v[28:29], v4 offset:640
    ds_read_b64_tr_b16 v[30:31], v4 offset:4224
    ds_read_b64_tr_b16 v[32:33], v4 offset:768
    ds_read_b64_tr_b16 v[34:35], v4 offset:4352
    s_waitcnt lgkmcnt(12)
    buffer_store_dwordx4 v[8:11], v3, s[52:55], s9 offen sc1
    s_add_u32 s9, s9, 229376
    s_waitcnt lgkmcnt(10)
    buffer_store_dwordx4 v[12:15], v3, s[52:55], s9 offen sc1
    s_add_u32 s9, s9, 229376
    s_waitcnt lgkmcnt(8)
    buffer_store_dwordx4 v[16:19], v3, s[52:55], s9 offen sc1
    s_add_u32 s9, s9, 229376
    s_waitcnt lgkmcnt(6)
    buffer_store_dwordx4 v[20:23], v3, s[52:55], s9 offen sc1
    s_add_u32 s9, s9, 229376
    s_waitcnt lgkmcnt(4)
    buffer_store_dwordx4 v[24:27], v3, s[52:55], s9 offen sc1
    s_add_u32 s9, s9, 229376
    s_waitcnt lgkmcnt(2)
    buffer_store_dwordx4 v[28:31], v3, s[52:55], s9 offen sc1
    s_add_u32 s9, s9, 229376
    s_waitcnt lgkmcnt(0)
    buffer_store_dwordx4 v[32:35], v3, s[52:55], s9 offen sc1
    s_add_u32 s5, s5, 64
    s_barrier
k12_wprep:
    s_lshr_b32 s6, s5, 2
    s_and_b32 s16, s5, 1
    s_bfe_u32 s5, s5, 0x10001
    s_cmp_eq_u32 s5, 0
    s_cselect_b32 s48, s32, s34
    s_cselect_b32 s49, s33, s35
    s_mov_b32 s50, 1605632
    s_mov_b32 s51, 0x20000
    s_mov_b32 s52, s46
    s_mov_b32 s53, s47
    s_mov_b32 s54, 0x2a00
    s_mov_b32 s55, 0x20000
    s_add_u32 s56, s46, 0x700000
    s_addc_u32 s57, s47, 0
    s_mov_b32 s58, 0x310000
    s_mov_b32 s59, 0x20000
    s_add_u32 s60, s46, 0xa80000
    s_addc_u32 s61, s47, 0
    s_mov_b32 s62, 0xe000
    s_mov_b32 s63, 0x20000
    v_lshrrev_b32 v3, 2, v0
    v_and_b32 v4, 3, v0
    s_mov_b32 s7, 14336
    v_mul_lo_u32 v5, v3, s7
    v_lshl_add_u32 v5, v4, 4, v5
    v_mov_b32 v6, 0x7ffffff0
    v_cmp_gt_u32 vcc, 56, v3
    s_nop 1
    v_cndmask_b32 v5, v6, v5, vcc
    v_lshlrev_b32 v6, 4, v3
    s_lshl_b32 s8, s6, 6
    s_mul_i32 s9, s16, 802816
    s_add_u32 s8, s8, s9
    buffer_load_dwordx4 v[40:43], v5, s[48:51], s8 offen
    s_add_u32 s8, s8, 3584
    buffer_load_dwordx4 v[44:47], v5, s[48:51], s8 offen
    s_add_u32 s8, s8, 3584
    buffer_load_dwordx4 v[48:51], v5, s[48:51], s8 offen
    s_add_u32 s8, s8, 3584
    buffer_load_dwordx4 v[52:55], v5, s[48:51], s8 offen
    s_cmp_lg_u32 s4, 0
    s_cbranch_scc1 wt_wp_done
    s_mov_b32 s78, 4194304
wt_wp_loop:
    buffer_load_dword v2, off, s[72:75], 0 offset:140 sc1
    s_waitcnt vmcnt(0)
    v_readfirstlane_b32 s79, v2
    s_nop 0
    s_cmp_lg_u32 s79, 0
    s_nop 2
    s_cbranch_scc1 wt_wp_done
    s_sub_u32 s78, s78, 1
    s_cmp_eq_u32 s78, 0
    s_cbranch_scc1 wt_wp_done
    s_sleep 6
    s_cmp_gt_u32 s78, 4194301
    s_cbranch_scc1 wt_wp_loop
    s_sleep 12
    s_branch wt_wp_loop
wt_wp_done:
    s_barrier
    s_setprio 0
    s_mul_i32 s70, s16, 896
    s_add_u32 s71, s70, 7168
    s_add_u32 s70, s70, 5376
    buffer_load_dwordx4 v[8:11], v6, s[52:55], s70 offen sc1
    buffer_load_dwordx4 v[16:19], v6, s[52:55], s71 offen sc1
    v_mul_u32_u24 v102, 320, v3
    v_lshl_add_u32 v102, v4, 4, v102
    s_waitcnt vmcnt(2)
    v_lshlrev_b32 v56, 16, v40
    v_and_b32 v57, 0xffff0000, v40
    v_lshlrev_b32 v58, 16, v41
    v_and_b32 v59, 0xffff0000, v41
    v_lshlrev_b32 v60, 16, v42
    v_and_b32 v61, 0xffff0000, v42
    v_lshlrev_b32 v62, 16, v43
    v_and_b32 v63, 0xffff0000, v43
    v_lshlrev_b32 v64, 16, v44
    v_and_b32 v65, 0xffff0000, v44
    v_lshlrev_b32 v66, 16, v45
    v_and_b32 v67, 0xffff0000, v45
    v_lshlrev_b32 v68, 16, v46
    v_and_b32 v69, 0xffff0000, v46
    v_lshlrev_b32 v70, 16, v47
    v_and_b32 v71, 0xffff0000, v47
    v_lshlrev_b32 v72, 16, v48
    v_and_b32 v73, 0xffff0000, v48
    v_lshlrev_b32 v74, 16, v49
    v_and_b32 v75, 0xffff0000, v49
    v_lshlrev_b32 v76, 16, v50
    v_and_b32 v77, 0xffff0000, v50
    v_lshlrev_b32 v78, 16, v51
    v_and_b32 v79, 0xffff0000, v51
    v_lshlrev_b32 v80, 16, v52
    v_and_b32 v81, 0xffff0000, v52
    v_lshlrev_b32 v82, 16, v53
    v_and_b32 v83, 0xffff0000, v53
    v_lshlrev_b32 v84, 16, v54
    v_and_b32 v85, 0xffff0000, v54
    v_lshlrev_b32 v86, 16, v55
    v_and_b32 v87, 0xffff0000, v55
    s_waitcnt vmcnt(0)
    v_add_f32 v24, 1.0, v16
    v_add_f32 v26, 1.0, v17
    v_add_f32 v28, 1.0, v18
    v_add_f32 v30, 1.0, v19
    v_cvt_pk_bf16_f32 v24, v24, v24
    v_lshlrev_b32 v24, 16, v24
    v_cvt_pk_bf16_f32 v26, v26, v26
    v_lshlrev_b32 v26, 16, v26
    v_cvt_pk_bf16_f32 v28, v28, v28
    v_lshlrev_b32 v28, 16, v28
    v_cvt_pk_bf16_f32 v30, v30, v30
    v_lshlrev_b32 v30, 16, v30
    v_mov_b32 v32, v8
    v_mov_b32 v34, v9
    v_mov_b32 v36, v10
    v_mov_b32 v38, v11
    v_pk_mul_f32 v[128:129], v[56:57], v[24:25] op_sel_hi:[1,0]
    v_pk_mul_f32 v[130:131], v[58:59], v[24:25] op_sel_hi:[1,0]
    v_pk_mul_f32 v[132:133], v[60:61], v[24:25] op_sel_hi:[1,0]
    v_pk_mul_f32 v[134:135], v[62:63], v[24:25] op_sel_hi:[1,0]
    v_pk_mul_f32 v[104:105], v[56:57], v[32:33] op_sel_hi:[1,0]
    v_pk_mul_f32 v[106:107], v[58:59], v[32:33] op_sel_hi:[1,0]
    v_pk_mul_f32 v[108:109], v[60:61], v[32:33] op_sel_hi:[1,0]
    v_pk_mul_f32 v[110:111], v[62:63], v[32:33] op_sel_hi:[1,0]
    v_cvt_pk_bf16_f32 v40, v128, v129
    v_cvt_pk_bf16_f32 v41, v130, v131
    v_cvt_pk_bf16_f32 v42, v132, v133
    v_cvt_pk_bf16_f32 v43, v134, v135
    ds_write_b128 v102, v[40:43] offset:0
    v_lshlrev_b32 v112, 16, v40
    v_and_b32 v113, 0xffff0000, v40
    v_lshlrev_b32 v114, 16, v41
    v_and_b32 v115, 0xffff0000, v41
    v_lshlrev_b32 v116, 16, v42
    v_and_b32 v117, 0xffff0000, v42
    v_lshlrev_b32 v118, 16, v43
    v_and_b32 v119, 0xffff0000, v43
    v_pk_mul_f32 v[128:129], v[64:65], v[26:27] op_sel_hi:[1,0]
    v_pk_mul_f32 v[130:131], v[66:67], v[26:27] op_sel_hi:[1,0]
    v_pk_mul_f32 v[132:133], v[68:69], v[26:27] op_sel_hi:[1,0]
    v_pk_mul_f32 v[134:135], v[70:71], v[26:27] op_sel_hi:[1,0]
    v_pk_fma_f32 v[104:105], v[64:65], v[34:35], v[104:105] op_sel_hi:[1,0,1]
    v_pk_fma_f32 v[106:107], v[66:67], v[34:35], v[106:107] op_sel_hi:[1,0,1]
    v_pk_fma_f32 v[108:109], v[68:69], v[34:35], v[108:109] op_sel_hi:[1,0,1]
    v_pk_fma_f32 v[110:111], v[70:71], v[34:35], v[110:111] op_sel_hi:[1,0,1]
    v_cvt_pk_bf16_f32 v44, v128, v129
    v_cvt_pk_bf16_f32 v45, v130, v131
    v_cvt_pk_bf16_f32 v46, v132, v133
    v_cvt_pk_bf16_f32 v47, v134, v135
    ds_write_b128 v102, v[44:47] offset:80
    v_lshlrev_b32 v120, 16, v44
    v_and_b32 v121, 0xffff0000, v44
    v_lshlrev_b32 v122, 16, v45
    v_and_b32 v123, 0xffff0000, v45
    v_lshlrev_b32 v124, 16, v46
    v_and_b32 v125, 0xffff0000, v46
    v_lshlrev_b32 v126, 16, v47
    v_and_b32 v127, 0xffff0000, v47
    v_pk_add_f32 v[112:113], v[112:113], v[120:121]
    v_pk_add_f32 v[114:115], v[114:115], v[122:123]
    v_pk_add_f32 v[116:117], v[116:117], v[124:125]
    v_pk_add_f32 v[118:119], v[118:119], v[126:127]
    v_pk_mul_f32 v[128:129], v[72:73], v[28:29] op_sel_hi:[1,0]
    v_pk_mul_f32 v[130:131], v[74:75], v[28:29] op_sel_hi:[1,0]
    v_pk_mul_f32 v[132:133], v[76:77], v[28:29] op_sel_hi:[1,0]
    v_pk_mul_f32 v[134:135], v[78:79], v[28:29] op_sel_hi:[1,0]
    v_pk_fma_f32 v[104:105], v[72:73], v[36:37], v[104:105] op_sel_hi:[1,0,1]
    v_pk_fma_f32 v[106:107], v[74:75], v[36:37], v[106:107] op_sel_hi:[1,0,1]
    v_pk_fma_f32 v[108:109], v[76:77], v[36:37], v[108:109] op_sel_hi:[1,0,1]
    v_pk_fma_f32 v[110:111], v[78:79], v[36:37], v[110:111] op_sel_hi:[1,0,1]
    v_cvt_pk_bf16_f32 v48, v128, v129
    v_cvt_pk_bf16_f32 v49, v130, v131
    v_cvt_pk_bf16_f32 v50, v132, v133
    v_cvt_pk_bf16_f32 v51, v134, v135
    ds_write_b128 v102, v[48:51] offset:160
    v_lshlrev_b32 v120, 16, v48
    v_and_b32 v121, 0xffff0000, v48
    v_lshlrev_b32 v122, 16, v49
    v_and_b32 v123, 0xffff0000, v49
    v_lshlrev_b32 v124, 16, v50
    v_and_b32 v125, 0xffff0000, v50
    v_lshlrev_b32 v126, 16, v51
    v_and_b32 v127, 0xffff0000, v51
    v_pk_add_f32 v[112:113], v[112:113], v[120:121]
    v_pk_add_f32 v[114:115], v[114:115], v[122:123]
    v_pk_add_f32 v[116:117], v[116:117], v[124:125]
    v_pk_add_f32 v[118:119], v[118:119], v[126:127]
    v_pk_mul_f32 v[128:129], v[80:81], v[30:31] op_sel_hi:[1,0]
    v_pk_mul_f32 v[130:131], v[82:83], v[30:31] op_sel_hi:[1,0]
    v_pk_mul_f32 v[132:133], v[84:85], v[30:31] op_sel_hi:[1,0]
    v_pk_mul_f32 v[134:135], v[86:87], v[30:31] op_sel_hi:[1,0]
    v_pk_fma_f32 v[104:105], v[80:81], v[38:39], v[104:105] op_sel_hi:[1,0,1]
    v_pk_fma_f32 v[106:107], v[82:83], v[38:39], v[106:107] op_sel_hi:[1,0,1]
    v_pk_fma_f32 v[108:109], v[84:85], v[38:39], v[108:109] op_sel_hi:[1,0,1]
    v_pk_fma_f32 v[110:111], v[86:87], v[38:39], v[110:111] op_sel_hi:[1,0,1]
    v_cvt_pk_bf16_f32 v52, v128, v129
    v_cvt_pk_bf16_f32 v53, v130, v131
    v_cvt_pk_bf16_f32 v54, v132, v133
    v_cvt_pk_bf16_f32 v55, v134, v135
    ds_write_b128 v102, v[52:55] offset:240
    v_lshlrev_b32 v120, 16, v52
    v_and_b32 v121, 0xffff0000, v52
    v_lshlrev_b32 v122, 16, v53
    v_and_b32 v123, 0xffff0000, v53
    v_lshlrev_b32 v124, 16, v54
    v_and_b32 v125, 0xffff0000, v54
    v_lshlrev_b32 v126, 16, v55
    v_and_b32 v127, 0xffff0000, v55
    v_pk_add_f32 v[112:113], v[112:113], v[120:121]
    v_pk_add_f32 v[114:115], v[114:115], v[122:123]
    v_pk_add_f32 v[116:117], v[116:117], v[124:125]
    v_pk_add_f32 v[118:119], v[118:119], v[126:127]
    v_add_f32_dpp v104, v104, v104 row_shr:4 row_mask:0xf bank_mask:0xf bound_ctrl:0
    v_add_f32_dpp v105, v105, v105 row_shr:4 row_mask:0xf bank_mask:0xf bound_ctrl:0
    v_add_f32_dpp v106, v106, v106 row_shr:4 row_mask:0xf bank_mask:0xf bound_ctrl:0
    v_add_f32_dpp v107, v107, v107 row_shr:4 row_mask:0xf bank_mask:0xf bound_ctrl:0
    v_add_f32_dpp v108, v108, v108 row_shr:4 row_mask:0xf bank_mask:0xf bound_ctrl:0
    v_add_f32_dpp v109, v109, v109 row_shr:4 row_mask:0xf bank_mask:0xf bound_ctrl:0
    v_add_f32_dpp v110, v110, v110 row_shr:4 row_mask:0xf bank_mask:0xf bound_ctrl:0
    v_add_f32_dpp v111, v111, v111 row_shr:4 row_mask:0xf bank_mask:0xf bound_ctrl:0
    v_add_f32_dpp v112, v112, v112 row_shr:4 row_mask:0xf bank_mask:0xf bound_ctrl:0
    v_add_f32_dpp v113, v113, v113 row_shr:4 row_mask:0xf bank_mask:0xf bound_ctrl:0
    v_add_f32_dpp v114, v114, v114 row_shr:4 row_mask:0xf bank_mask:0xf bound_ctrl:0
    v_add_f32_dpp v115, v115, v115 row_shr:4 row_mask:0xf bank_mask:0xf bound_ctrl:0
    v_add_f32_dpp v116, v116, v116 row_shr:4 row_mask:0xf bank_mask:0xf bound_ctrl:0
    v_add_f32_dpp v117, v117, v117 row_shr:4 row_mask:0xf bank_mask:0xf bound_ctrl:0
    v_add_f32_dpp v118, v118, v118 row_shr:4 row_mask:0xf bank_mask:0xf bound_ctrl:0
    v_add_f32_dpp v119, v119, v119 row_shr:4 row_mask:0xf bank_mask:0xf bound_ctrl:0
    v_add_f32_dpp v104, v104, v104 row_shr:8 row_mask:0xf bank_mask:0xf bound_ctrl:0
    v_add_f32_dpp v105, v105, v105 row_shr:8 row_mask:0xf bank_mask:0xf bound_ctrl:0
    v_add_f32_dpp v106, v106, v106 row_shr:8 row_mask:0xf bank_mask:0xf bound_ctrl:0
    v_add_f32_dpp v107, v107, v107 row_shr:8 row_mask:0xf bank_mask:0xf bound_ctrl:0
    v_add_f32_dpp v108, v108, v108 row_shr:8 row_mask:0xf bank_mask:0xf bound_ctrl:0
    v_add_f32_dpp v109, v109, v109 row_shr:8 row_mask:0xf bank_mask:0xf bound_ctrl:0
    v_add_f32_dpp v110, v110, v110 row_shr:8 row_mask:0xf bank_mask:0xf bound_ctrl:0
    v_add_f32_dpp v111, v111, v111 row_shr:8 row_mask:0xf bank_mask:0xf bound_ctrl:0
    v_add_f32_dpp v112, v112, v112 row_shr:8 row_mask:0xf bank_mask:0xf bound_ctrl:0
    v_add_f32_dpp v113, v113, v113 row_shr:8 row_mask:0xf bank_mask:0xf bound_ctrl:0
    v_add_f32_dpp v114, v114, v114 row_shr:8 row_mask:0xf bank_mask:0xf bound_ctrl:0
    v_add_f32_dpp v115, v115, v115 row_shr:8 row_mask:0xf bank_mask:0xf bound_ctrl:0
    v_add_f32_dpp v116, v116, v116 row_shr:8 row_mask:0xf bank_mask:0xf bound_ctrl:0
    v_add_f32_dpp v117, v117, v117 row_shr:8 row_mask:0xf bank_mask:0xf bound_ctrl:0
    v_add_f32_dpp v118, v118, v118 row_shr:8 row_mask:0xf bank_mask:0xf bound_ctrl:0
    v_add_f32_dpp v119, v119, v119 row_shr:8 row_mask:0xf bank_mask:0xf bound_ctrl:0
    v_lshrrev_b32 v8, 4, v0
    v_lshl_add_u32 v8, v8, 2, v4
    v_lshlrev_b32 v8, 6, v8
    v_add_u32 v8, 20480, v8
    s_mov_b32 exec_lo, 0xf000f000
    s_mov_b32 exec_hi, 0xf000f000
    ds_write_b128 v8, v[104:107] offset:0
    ds_write_b128 v8, v[108:111] offset:16
    ds_write_b128 v8, v[112:115] offset:32
    ds_write_b128 v8, v[116:119] offset:48
    s_mov_b64 exec, -1
    s_waitcnt lgkmcnt(0)
    s_barrier
    v_lshrrev_b32 v8, 2, v1
    v_mul_u32_u24 v8, 80, v8
    v_and_b32 v9, 3, v1
    v_lshl_add_u32 v8, v9, 3, v8
    s_and_b32 s9, s4, 1
    s_lshr_b32 s10, s4, 1
    s_lshl_b32 s11, s9, 5
    s_mul_i32 s12, s10, 10240
    s_add_u32 s11, s11, s12
    v_add_u32 v8, s11, v8
    ds_read_b64_tr_b16 v[16:17], v8 offset:0
    ds_read_b64_tr_b16 v[18:19], v8 offset:1280
    ds_read_b64_tr_b16 v[20:21], v8 offset:2560
    ds_read_b64_tr_b16 v[22:23], v8 offset:3840
    ds_read_b64_tr_b16 v[24:25], v8 offset:5120
    ds_read_b64_tr_b16 v[26:27], v8 offset:6400
    ds_read_b64_tr_b16 v[28:29], v8 offset:7680
    ds_read_b64_tr_b16 v[30:31], v8 offset:8960
    v_and_b32 v10, 31, v1
    v_lshrrev_b32 v11, 3, v10
    v_lshlrev_b32 v11, 6, v11
    v_and_b32 v12, 7, v10
    v_lshl_add_u32 v11, v12, 2, v11
    v_lshrrev_b32 v12, 5, v1
    v_lshl_add_u32 v11, v12, 5, v11
    v_add_u32 v11, 20480, v11
    ds_read_b32 v48, v11 offset:0
    ds_read_b32 v49, v11 offset:256
    ds_read_b32 v50, v11 offset:512
    ds_read_b32 v51, v11 offset:768
    ds_read_b32 v52, v11 offset:1024
    ds_read_b32 v53, v11 offset:1280
    ds_read_b32 v54, v11 offset:1536
    ds_read_b32 v55, v11 offset:1792
    ds_read_b32 v56, v11 offset:2048
    ds_read_b32 v57, v11 offset:2304
    ds_read_b32 v58, v11 offset:2560
    ds_read_b32 v59, v11 offset:2816
    ds_read_b32 v60, v11 offset:3072
    ds_read_b32 v61, v11 offset:3328
    ds_read_b32 v62, v11 offset:3584
    ds_read_b32 v63, v11 offset:3840
    s_lshl_b32 s13, s6, 1
    s_add_u32 s13, s13, s9
    s_mul_i32 s14, s13, 14
    s_mul_i32 s15, s16, 7
    s_add_u32 s14, s14, s15
    s_lshl_b32 s15, s10, 2
    s_add_u32 s14, s14, s15
    s_lshl_b32 s14, s14, 1
    s_add_u32 s14, s14, s5
    s_lshl_b32 s14, s14, 10
    v_lshlrev_b32 v13, 4, v1
    s_waitcnt lgkmcnt(0)
    buffer_store_dwordx4 v[16:19], v13, s[56:59], s14 offen offset:0 sc1
    buffer_store_dwordx4 v[20:23], v13, s[56:59], s14 offen offset:2048 sc1
    s_add_u32 s14, s14, 4096
    buffer_store_dwordx4 v[24:27], v13, s[56:59], s14 offen offset:0 sc1
    s_cmp_ge_u32 s4, 2
    s_nop 0
    s_cbranch_scc1 k12_kernel_done
    buffer_store_dwordx4 v[28:31], v13, s[56:59], s14 offen offset:2048 sc1
    s_add_u32 s14, s14, 4096
    s_cmp_lg_u32 s4, 0
    s_cbranch_scc1 k12_kernel_done
    v_add_f32 v48, v48, v56
    v_add_f32 v49, v49, v57
    v_add_f32 v50, v50, v58
    v_add_f32 v51, v51, v59
    v_add_f32 v52, v52, v60
    v_add_f32 v53, v53, v61
    v_add_f32 v54, v54, v62
    v_add_f32 v55, v55, v63
    v_add_f32 v48, v48, v52
    v_add_f32 v49, v49, v53
    v_add_f32 v50, v50, v54
    v_add_f32 v51, v51, v55
    v_add_f32 v48, v48, v50
    v_add_f32 v49, v49, v51
    v_add_f32 v48, v48, v49
    v_sub_u32 v12, 1, v12
    v_mul_u32_u24 v12, 7168, v12
    v_lshl_add_u32 v12, v10, 2, v12
    s_mul_i32 s12, s5, 14336
    s_mul_i32 s13, s16, 28672
    s_add_u32 s12, s12, s13
    s_lshl_b32 s13, s6, 7
    s_add_u32 s12, s12, s13
    buffer_store_dword v48, v12, s[60:63], s12 offen
    s_endpgm
k12_kernel_done:
    s_endpgm
k12_kernel_exit:
    s_endpgm
.globl k34_kernel
.p2align 8
.type k34_kernel,@function
k34_kernel:
    s_cmp_ge_u32 s2, 256
    s_cbranch_scc1 k34_kernel_exit
    s_load_dwordx16 s[16:31], s[0:1], 0
    s_load_dwordx16 s[32:47], s[0:1], 64
    v_and_b32 v1, 63, v0
    v_lshrrev_b32 v2, 6, v0
    s_nop 0
    v_readfirstlane_b32 s4, v2
    s_waitcnt lgkmcnt(0)
    s_and_b32 s5, s2, 7
    s_lshr_b32 s6, s2, 3
    s_lshr_b32 s7, s5, 1
    s_lshl_b32 s7, s7, 2
    s_and_b32 s8, s6, 3
    s_add_u32 s7, s7, s8
    s_and_b32 s8, s5, 1
    s_lshl_b32 s8, s8, 3
    s_lshr_b32 s9, s6, 2
    s_add_u32 s8, s8, s9
    s_add_u32 s48, s46, 0x500000
    s_addc_u32 s49, s47, 0
    s_mov_b32 s50, 0x1c0000
    s_mov_b32 s51, 0x20000
    s_add_u32 s52, s46, 0x700000
    s_addc_u32 s53, s47, 0
    s_mov_b32 s54, 0x310000
    s_mov_b32 s55, 0x20000
    s_add_u32 s56, s46, 0xa80000
    s_addc_u32 s57, s47, 0
    s_mov_b32 s58, 0xe000
    s_mov_b32 s59, 0x20000
    s_add_u32 s60, s46, 0xd00000
    s_addc_u32 s61, s47, 0
    s_mov_b32 s62, 0x700000
    s_mov_b32 s63, 0x20000
    s_add_u32 s64, s46, 0xb00000
    s_addc_u32 s65, s47, 0
    s_mov_b32 s66, 0x188000
    s_mov_b32 s67, 0x20000
    s_add_u32 s72, s46, 0x8000
    s_addc_u32 s73, s47, 0
    s_mov_b32 s74, 0x1000
    s_mov_b32 s75, 0x20000
    v_lshrrev_b32 v3, 4, v1
    v_and_b32 v4, 15, v1
    v_lshlrev_b32 v5, 1, v3
    v_xor_b32 v6, v4, v5
    v_lshlrev_b32 v6, 4, v6
    v_lshl_add_u32 v6, v3, 12, v6
    s_and_b32 s10, s4, 1
    s_lshl_b32 s10, s10, 7
    v_xor_b32 v6, s10, v6
    s_lshl_b32 s11, s4, 14
    s_lshl_b32 s12, s7, 8
    s_add_u32 s11, s11, s12
    s_lshl_b32 s12, s4, 10
    s_mov_b32 m0, s12
    s_nop 0
    buffer_load_dwordx4 v6, s[48:51], s11 offen lds
    s_add_u32 s11, s11, 131072
    s_add_u32 s12, s12, 8192
    s_mov_b32 m0, s12
    s_nop 0
    buffer_load_dwordx4 v6, s[48:51], s11 offen lds
    s_add_u32 s11, s11, 131072
    s_add_u32 s12, s12, 8192
    s_mov_b32 m0, s12
    s_nop 0
    buffer_load_dwordx4 v6, s[48:51], s11 offen lds
    s_add_u32 s11, s11, 131072
    s_add_u32 s12, s12, 8192
    s_mov_b32 m0, s12
    s_nop 0
    buffer_load_dwordx4 v6, s[48:51], s11 offen lds
    s_add_u32 s11, s11, 131072
    s_add_u32 s12, s12, 8192
    v_lshrrev_b32 v5, 2, v1
    v_and_b32 v2, 7, v5
    v_lshlrev_b32 v5, 8, v5
    v_and_b32 v40, 3, v1
    v_lshl_add_u32 v5, v40, 3, v5
    v_xor_b32 v8, 0, v2
    v_lshl_add_u32 v8, v8, 5, v5
    v_add_u32 v16, 0x10000, v8
    v_xor_b32 v9, 1, v2
    v_lshl_add_u32 v9, v9, 5, v5
    v_add_u32 v17, 0x10000, v9
    v_xor_b32 v10, 2, v2
    v_lshl_add_u32 v10, v10, 5, v5
    v_add_u32 v18, 0x10000, v10
    v_xor_b32 v11, 3, v2
    v_lshl_add_u32 v11, v11, 5, v5
    v_add_u32 v19, 0x10000, v11
    v_xor_b32 v12, 4, v2
    v_lshl_add_u32 v12, v12, 5, v5
    v_add_u32 v20, 0x10000, v12
    v_xor_b32 v13, 5, v2
    v_lshl_add_u32 v13, v13, 5, v5
    v_add_u32 v21, 0x10000, v13
    v_xor_b32 v14, 6, v2
    v_lshl_add_u32 v14, v14, 5, v5
    v_add_u32 v22, 0x10000, v14
    v_xor_b32 v15, 7, v2
    v_lshl_add_u32 v15, v15, 5, v5
    v_add_u32 v23, 0x10000, v15
    v_lshlrev_b32 v250, 4, v1
    s_lshr_b32 s16, s8, 3
    s_and_b32 s17, s8, 7
    s_mul_i32 s22, s17, 56
    s_mul_i32 s23, s4, 7
    s_add_u32 s22, s22, s23
    s_lshl_b32 s22, s22, 12
    s_cmp_eq_u32 s4, 0
    s_cbranch_scc1 k34_stats
    s_mul_i32 s13, s8, 7
    s_add_u32 s13, s13, s4
    s_sub_u32 s13, s13, 1
    v_lshlrev_b32 v5, 4, v3
    s_lshl_b32 s14, s13, 6
    s_mul_i32 s15, s13, 28672
    s_mov_b32 s19, s14
    s_mov_b32 s14, s15
    buffer_load_dwordx4 v[56:59], v250, s[52:55], s14 offen offset:0
    buffer_load_dwordx4 v[60:63], v250, s[52:55], s14 offen offset:1024
    buffer_load_dwordx4 v[64:67], v250, s[52:55], s14 offen offset:2048
    buffer_load_dwordx4 v[68:71], v250, s[52:55], s14 offen offset:3072
    s_add_u32 s14, s14, 4096
    v_mov_b32 v251, v5
    s_waitcnt vmcnt(4)
    s_barrier
    ds_read_b64_tr_b16 v[24:25], v8 offset:0
    ds_read_b64_tr_b16 v[26:27], v8 offset:4096
    ds_read_b64_tr_b16 v[28:29], v9 offset:0
    ds_read_b64_tr_b16 v[30:31], v9 offset:4096
    ds_read_b64_tr_b16 v[32:33], v10 offset:0
    ds_read_b64_tr_b16 v[34:35], v10 offset:4096
    ds_read_b64_tr_b16 v[36:37], v11 offset:0
    ds_read_b64_tr_b16 v[38:39], v11 offset:4096
    s_waitcnt vmcnt(2) lgkmcnt(6)
    v_mfma_f32_16x16x32_bf16 v[168:171], v[56:59], v[24:27], 0
    v_mfma_f32_16x16x32_bf16 v[200:203], v[60:63], v[24:27], 0
    s_mov_b32 m0, s12
    s_nop 0
    buffer_load_dwordx4 v6, s[48:51], s11 offen lds
    s_add_u32 s11, s11, 131072
    s_add_u32 s12, s12, 8192
    buffer_load_dwordx4 v[72:75], v250, s[52:55], s14 offen offset:0
    buffer_load_dwordx4 v[76:79], v250, s[52:55], s14 offen offset:1024
    ds_read_b64_tr_b16 v[24:25], v12 offset:0
    ds_read_b64_tr_b16 v[26:27], v12 offset:4096
    s_waitcnt lgkmcnt(6)
    v_mfma_f32_16x16x32_bf16 v[172:175], v[56:59], v[28:31], 0
    v_mfma_f32_16x16x32_bf16 v[204:207], v[60:63], v[28:31], 0
    buffer_load_dwordx4 v[80:83], v250, s[52:55], s14 offen offset:2048
    buffer_load_dwordx4 v[84:87], v250, s[52:55], s14 offen offset:3072
    s_add_u32 s14, s14, 4096
    ds_read_b64_tr_b16 v[28:29], v13 offset:0
    ds_read_b64_tr_b16 v[30:31], v13 offset:4096
    s_waitcnt lgkmcnt(6)
    v_mfma_f32_16x16x32_bf16 v[176:179], v[56:59], v[32:35], 0
    v_mfma_f32_16x16x32_bf16 v[208:211], v[60:63], v[32:35], 0
    s_mov_b32 m0, s12
    s_nop 0
    buffer_load_dwordx4 v6, s[48:51], s11 offen lds
    s_add_u32 s11, s11, 131072
    s_add_u32 s12, s12, 8192
    buffer_load_dwordx4 v[88:91], v250, s[52:55], s14 offen offset:0
    buffer_load_dwordx4 v[92:95], v250, s[52:55], s14 offen offset:1024
    ds_read_b64_tr_b16 v[32:33], v14 offset:0
    ds_read_b64_tr_b16 v[34:35], v14 offset:4096
    s_waitcnt lgkmcnt(6)
    v_mfma_f32_16x16x32_bf16 v[180:183], v[56:59], v[36:39], 0
    v_mfma_f32_16x16x32_bf16 v[212:215], v[60:63], v[36:39], 0
    ds_read_b64_tr_b16 v[36:37], v15 offset:0
    ds_read_b64_tr_b16 v[38:39], v15 offset:4096
    s_waitcnt lgkmcnt(6)
    v_mfma_f32_16x16x32_bf16 v[184:187], v[56:59], v[24:27], 0
    v_mfma_f32_16x16x32_bf16 v[216:219], v[60:63], v[24:27], 0
    s_mov_b32 m0, s12
    s_nop 0
    buffer_load_dwordx4 v6, s[48:51], s11 offen lds
    s_add_u32 s11, s11, 131072
    s_add_u32 s12, s12, 8192
    ds_read_b64_tr_b16 v[24:25], v8 offset:8192
    ds_read_b64_tr_b16 v[26:27], v8 offset:12288
    s_waitcnt lgkmcnt(6)
    v_mfma_f32_16x16x32_bf16 v[188:191], v[56:59], v[28:31], 0
    v_mfma_f32_16x16x32_bf16 v[220:223], v[60:63], v[28:31], 0
    ds_read_b64_tr_b16 v[28:29], v9 offset:8192
    ds_read_b64_tr_b16 v[30:31], v9 offset:12288
    s_waitcnt lgkmcnt(6)
    v_mfma_f32_16x16x32_bf16 v[192:195], v[56:59], v[32:35], 0
    v_mfma_f32_16x16x32_bf16 v[224:227], v[60:63], v[32:35], 0
    s_mov_b32 m0, s12
    s_nop 0
    buffer_load_dwordx4 v6, s[48:51], s11 offen lds
    s_add_u32 s11, s11, 131072
    s_add_u32 s12, s12, 8192
    ds_read_b64_tr_b16 v[32:33], v10 offset:8192
    ds_read_b64_tr_b16 v[34:35], v10 offset:12288
    s_waitcnt lgkmcnt(6)
    v_mfma_f32_16x16x32_bf16 v[196:199], v[56:59], v[36:39], 0
    v_mfma_f32_16x16x32_bf16 v[228:231], v[60:63], v[36:39], 0
    ds_read_b64_tr_b16 v[36:37], v11 offset:8192
    ds_read_b64_tr_b16 v[38:39], v11 offset:12288
    s_waitcnt vmcnt(10) lgkmcnt(6)
    v_mfma_f32_16x16x32_bf16 v[168:171], v[64:67], v[24:27], v[168:171]
    v_mfma_f32_16x16x32_bf16 v[200:203], v[68:71], v[24:27], v[200:203]
    s_mov_b32 m0, s12
    s_nop 0
    buffer_load_dwordx4 v6, s[48:51], s11 offen lds
    s_add_u32 s11, s11, 131072
    s_add_u32 s12, s12, 8192
    ds_read_b64_tr_b16 v[24:25], v12 offset:8192
    ds_read_b64_tr_b16 v[26:27], v12 offset:12288
    s_waitcnt lgkmcnt(6)
    v_mfma_f32_16x16x32_bf16 v[172:175], v[64:67], v[28:31], v[172:175]
    v_mfma_f32_16x16x32_bf16 v[204:207], v[68:71], v[28:31], v[204:207]
    buffer_load_dwordx4 v[96:99], v250, s[52:55], s14 offen offset:2048
    buffer_load_dwordx4 v[100:103], v250, s[52:55], s14 offen offset:3072
    s_add_u32 s14, s14, 4096
    ds_read_b64_tr_b16 v[28:29], v13 offset:8192
    ds_read_b64_tr_b16 v[30:31], v13 offset:12288
    s_waitcnt lgkmcnt(6)
    v_mfma_f32_16x16x32_bf16 v[176:179], v[64:67], v[32:35], v[176:179]
    v_mfma_f32_16x16x32_bf16 v[208:211], v[68:71], v[32:35], v[208:211]
    s_mov_b32 m0, s12
    s_nop 0
    buffer_load_dwordx4 v6, s[48:51], s11 offen lds
    s_add_u32 s11, s11, 131072
    s_add_u32 s12, s12, 8192
    ds_read_b64_tr_b16 v[32:33], v14 offset:8192
    ds_read_b64_tr_b16 v[34:35], v14 offset:12288
    s_waitcnt lgkmcnt(6)
    v_mfma_f32_16x16x32_bf16 v[180:183], v[64:67], v[36:39], v[180:183]
    v_mfma_f32_16x16x32_bf16 v[212:215], v[68:71], v[36:39], v[212:215]
    buffer_load_dwordx4 v[56:59], v250, s[64:67], s22 offen offset:0
    ds_read_b64_tr_b16 v[36:37], v15 offset:8192
    ds_read_b64_tr_b16 v[38:39], v15 offset:12288
    s_waitcnt lgkmcnt(6)
    v_mfma_f32_16x16x32_bf16 v[184:187], v[64:67], v[24:27], v[184:187]
    v_mfma_f32_16x16x32_bf16 v[216:219], v[68:71], v[24:27], v[216:219]
    s_mov_b32 m0, s12
    s_nop 0
    buffer_load_dwordx4 v6, s[48:51], s11 offen lds
    s_add_u32 s11, s11, 131072
    s_add_u32 s12, s12, 8192
    ds_read_b64_tr_b16 v[24:25], v8 offset:16384
    ds_read_b64_tr_b16 v[26:27], v8 offset:20480
    s_waitcnt lgkmcnt(6)
    v_mfma_f32_16x16x32_bf16 v[188:191], v[64:67], v[28:31], v[188:191]
    v_mfma_f32_16x16x32_bf16 v[220:223], v[68:71], v[28:31], v[220:223]
    buffer_load_dwordx4 v[60:63], v250, s[64:67], s22 offen offset:1024
    ds_read_b64_tr_b16 v[28:29], v9 offset:16384
    ds_read_b64_tr_b16 v[30:31], v9 offset:20480
    s_waitcnt lgkmcnt(6)
    v_mfma_f32_16x16x32_bf16 v[192:195], v[64:67], v[32:35], v[192:195]
    v_mfma_f32_16x16x32_bf16 v[224:227], v[68:71], v[32:35], v[224:227]
    s_mov_b32 m0, s12
    s_nop 0
    buffer_load_dwordx4 v6, s[48:51], s11 offen lds
    s_add_u32 s11, s11, 131072
    s_add_u32 s12, s12, 8192
    ds_read_b64_tr_b16 v[32:33], v10 offset:16384
    ds_read_b64_tr_b16 v[34:35], v10 offset:20480
    s_waitcnt lgkmcnt(6)
    v_mfma_f32_16x16x32_bf16 v[196:199], v[64:67], v[36:39], v[196:199]
    v_mfma_f32_16x16x32_bf16 v[228:231], v[68:71], v[36:39], v[228:231]
    ds_read_b64_tr_b16 v[36:37], v11 offset:16384
    ds_read_b64_tr_b16 v[38:39], v11 offset:20480
    s_waitcnt vmcnt(15) lgkmcnt(6)
    v_mfma_f32_16x16x32_bf16 v[168:171], v[72:75], v[24:27], v[168:171]
    v_mfma_f32_16x16x32_bf16 v[200:203], v[76:79], v[24:27], v[200:203]
    s_mov_b32 m0, s12
    s_nop 0
    buffer_load_dwordx4 v6, s[48:51], s11 offen lds
    s_add_u32 s11, s11, 131072
    s_add_u32 s12, s12, 8192
    ds_read_b64_tr_b16 v[24:25], v12 offset:16384
    ds_read_b64_tr_b16 v[26:27], v12 offset:20480
    s_waitcnt lgkmcnt(6)
    v_mfma_f32_16x16x32_bf16 v[172:175], v[72:75], v[28:31], v[172:175]
    v_mfma_f32_16x16x32_bf16 v[204:207], v[76:79], v[28:31], v[204:207]
    buffer_load_dwordx4 v[104:107], v250, s[52:55], s14 offen offset:0
    buffer_load_dwordx4 v[108:111], v250, s[52:55], s14 offen offset:1024
    ds_read_b64_tr_b16 v[28:29], v13 offset:16384
    ds_read_b64_tr_b16 v[30:31], v13 offset:20480
    s_waitcnt lgkmcnt(6)
    v_mfma_f32_16x16x32_bf16 v[176:179], v[72:75], v[32:35], v[176:179]
    v_mfma_f32_16x16x32_bf16 v[208:211], v[76:79], v[32:35], v[208:211]
    s_mov_b32 m0, s12
    s_nop 0
    buffer_load_dwordx4 v6, s[48:51], s11 offen lds
    ds_read_b64_tr_b16 v[32:33], v14 offset:16384
    ds_read_b64_tr_b16 v[34:35], v14 offset:20480
    s_waitcnt lgkmcnt(6)
    v_mfma_f32_16x16x32_bf16 v[180:183], v[72:75], v[36:39], v[180:183]
    v_mfma_f32_16x16x32_bf16 v[212:215], v[76:79], v[36:39], v[212:215]
    buffer_load_dwordx4 v[64:67], v250, s[64:67], s22 offen offset:2048
    ds_read_b64_tr_b16 v[36:37], v15 offset:16384
    ds_read_b64_tr_b16 v[38:39], v15 offset:20480
    s_waitcnt lgkmcnt(6)
    v_mfma_f32_16x16x32_bf16 v[184:187], v[72:75], v[24:27], v[184:187]
    v_mfma_f32_16x16x32_bf16 v[216:219], v[76:79], v[24:27], v[216:219]
    ds_read_b64_tr_b16 v[24:25], v8 offset:24576
    ds_read_b64_tr_b16 v[26:27], v8 offset:28672
    s_waitcnt lgkmcnt(6)
    v_mfma_f32_16x16x32_bf16 v[188:191], v[72:75], v[28:31], v[188:191]
    v_mfma_f32_16x16x32_bf16 v[220:223], v[76:79], v[28:31], v[220:223]
    buffer_load_dwordx4 v[68:71], v250, s[64:67], s22 offen offset:3072
    s_add_u32 s22, s22, 4096
    ds_read_b64_tr_b16 v[28:29], v9 offset:24576
    ds_read_b64_tr_b16 v[30:31], v9 offset:28672
    s_waitcnt lgkmcnt(6)
    v_mfma_f32_16x16x32_bf16 v[192:195], v[72:75], v[32:35], v[192:195]
    v_mfma_f32_16x16x32_bf16 v[224:227], v[76:79], v[32:35], v[224:227]
    ds_read_b64_tr_b16 v[32:33], v10 offset:24576
    ds_read_b64_tr_b16 v[34:35], v10 offset:28672
    s_waitcnt lgkmcnt(6)
    v_mfma_f32_16x16x32_bf16 v[196:199], v[72:75], v[36:39], v[196:199]
    v_mfma_f32_16x16x32_bf16 v[228:231], v[76:79], v[36:39], v[228:231]
    ds_read_b64_tr_b16 v[36:37], v11 offset:24576
    ds_read_b64_tr_b16 v[38:39], v11 offset:28672
    s_waitcnt vmcnt(19) lgkmcnt(6)
    v_mfma_f32_16x16x32_bf16 v[168:171], v[80:83], v[24:27], v[168:171]
    v_mfma_f32_16x16x32_bf16 v[200:203], v[84:87], v[24:27], v[200:203]
    ds_read_b64_tr_b16 v[24:25], v12 offset:24576
    ds_read_b64_tr_b16 v[26:27], v12 offset:28672
    s_waitcnt lgkmcnt(6)
    v_mfma_f32_16x16x32_bf16 v[172:175], v[80:83], v[28:31], v[172:175]
    v_mfma_f32_16x16x32_bf16 v[204:207], v[84:87], v[28:31], v[204:207]
    buffer_load_dwordx4 v[112:115], v250, s[52:55], s14 offen offset:2048
    buffer_load_dwordx4 v[116:119], v250, s[52:55], s14 offen offset:3072
    s_add_u32 s14, s14, 4096
    ds_read_b64_tr_b16 v[28:29], v13 offset:24576
    ds_read_b64_tr_b16 v[30:31], v13 offset:28672
    s_waitcnt lgkmcnt(6)
    v_mfma_f32_16x16x32_bf16 v[176:179], v[80:83], v[32:35], v[176:179]
    v_mfma_f32_16x16x32_bf16 v[208:211], v[84:87], v[32:35], v[208:211]
    ds_read_b64_tr_b16 v[32:33], v14 offset:24576
    ds_read_b64_tr_b16 v[34:35], v14 offset:28672
    s_waitcnt lgkmcnt(6)
    v_mfma_f32_16x16x32_bf16 v[180:183], v[80:83], v[36:39], v[180:183]
    v_mfma_f32_16x16x32_bf16 v[212:215], v[84:87], v[36:39], v[212:215]
    buffer_load_dwordx4 v[72:75], v250, s[64:67], s22 offen offset:0
    ds_read_b64_tr_b16 v[36:37], v15 offset:24576
    ds_read_b64_tr_b16 v[38:39], v15 offset:28672
    s_waitcnt lgkmcnt(6)
    v_mfma_f32_16x16x32_bf16 v[184:187], v[80:83], v[24:27], v[184:187]
    v_mfma_f32_16x16x32_bf16 v[216:219], v[84:87], v[24:27], v[216:219]
    s_waitcnt vmcnt(5)
    s_barrier
    ds_read_b64_tr_b16 v[24:25], v8 offset:32768
    ds_read_b64_tr_b16 v[26:27], v8 offset:36864
    s_waitcnt lgkmcnt(6)
    v_mfma_f32_16x16x32_bf16 v[188:191], v[80:83], v[28:31], v[188:191]
    v_mfma_f32_16x16x32_bf16 v[220:223], v[84:87], v[28:31], v[220:223]
    buffer_load_dwordx4 v[76:79], v250, s[64:67], s22 offen offset:1024
    ds_read_b64_tr_b16 v[28:29], v9 offset:32768
    ds_read_b64_tr_b16 v[30:31], v9 offset:36864
    s_waitcnt lgkmcnt(6)
    v_mfma_f32_16x16x32_bf16 v[192:195], v[80:83], v[32:35], v[192:195]
    v_mfma_f32_16x16x32_bf16 v[224:227], v[84:87], v[32:35], v[224:227]
    ds_read_b64_tr_b16 v[32:33], v10 offset:32768
    ds_read_b64_tr_b16 v[34:35], v10 offset:36864
    s_waitcnt lgkmcnt(6)
    v_mfma_f32_16x16x32_bf16 v[196:199], v[80:83], v[36:39], v[196:199]
    v_mfma_f32_16x16x32_bf16 v[228:231], v[84:87], v[36:39], v[228:231]
    ds_read_b64_tr_b16 v[36:37], v11 offset:32768
    ds_read_b64_tr_b16 v[38:39], v11 offset:36864
    s_waitcnt vmcnt(20) lgkmcnt(6)
    v_mfma_f32_16x16x32_bf16 v[168:171], v[88:91], v[24:27], v[168:171]
    v_mfma_f32_16x16x32_bf16 v[200:203], v[92:95], v[24:27], v[200:203]
    ds_read_b64_tr_b16 v[24:25], v12 offset:32768
    ds_read_b64_tr_b16 v[26:27], v12 offset:36864
    s_waitcnt lgkmcnt(6)
    v_mfma_f32_16x16x32_bf16 v[172:175], v[88:91], v[28:31], v[172:175]
    v_mfma_f32_16x16x32_bf16 v[204:207], v[92:95], v[28:31], v[204:207]
    buffer_load_dwordx4 v[120:123], v250, s[52:55], s14 offen offset:0
    buffer_load_dwordx4 v[124:127], v250, s[52:55], s14 offen offset:1024
    ds_read_b64_tr_b16 v[28:29], v13 offset:32768
    ds_read_b64_tr_b16 v[30:31], v13 offset:36864
    s_waitcnt lgkmcnt(6)
    v_mfma_f32_16x16x32_bf16 v[176:179], v[88:91], v[32:35], v[176:179]
    v_mfma_f32_16x16x32_bf16 v[208:211], v[92:95], v[32:35], v[208:211]
    ds_read_b64_tr_b16 v[32:33], v14 offset:32768
    ds_read_b64_tr_b16 v[34:35], v14 offset:36864
    s_waitcnt lgkmcnt(6)
    v_mfma_f32_16x16x32_bf16 v[180:183], v[88:91], v[36:39], v[180:183]
    v_mfma_f32_16x16x32_bf16 v[212:215], v[92:95], v[36:39], v[212:215]
    buffer_load_dwordx4 v[80:83], v250, s[64:67], s22 offen offset:2048
    ds_read_b64_tr_b16 v[36:37], v15 offset:32768
    ds_read_b64_tr_b16 v[38:39], v15 offset:36864
    s_waitcnt lgkmcnt(6)
    v_mfma_f32_16x16x32_bf16 v[184:187], v[88:91], v[24:27], v[184:187]
    v_mfma_f32_16x16x32_bf16 v[216:219], v[92:95], v[24:27], v[216:219]
    ds_read_b64_tr_b16 v[24:25], v8 offset:40960
    ds_read_b64_tr_b16 v[26:27], v8 offset:45056
    s_waitcnt lgkmcnt(6)
    v_mfma_f32_16x16x32_bf16 v[188:191], v[88:91], v[28:31], v[188:191]
    v_mfma_f32_16x16x32_bf16 v[220:223], v[92:95], v[28:31], v[220:223]
    buffer_load_dwordx4 v[84:87], v250, s[64:67], s22 offen offset:3072
    s_add_u32 s22, s22, 4096
    ds_read_b64_tr_b16 v[28:29], v9 offset:40960
    ds_read_b64_tr_b16 v[30:31], v9 offset:45056
    s_waitcnt lgkmcnt(6)
    v_mfma_f32_16x16x32_bf16 v[192:195], v[88:91], v[32:35], v[192:195]
    v_mfma_f32_16x16x32_bf16 v[224:227], v[92:95], v[32:35], v[224:227]
    ds_read_b64_tr_b16 v[32:33], v10 offset:40960
    ds_read_b64_tr_b16 v[34:35], v10 offset:45056
    s_waitcnt lgkmcnt(6)
    v_mfma_f32_16x16x32_bf16 v[196:199], v[88:91], v[36:39], v[196:199]
    v_mfma_f32_16x16x32_bf16 v[228:231], v[92:95], v[36:39], v[228:231]
    ds_read_b64_tr_b16 v[36:37], v11 offset:40960
    ds_read_b64_tr_b16 v[38:39], v11 offset:45056
    s_waitcnt vmcnt(19) lgkmcnt(6)
    v_mfma_f32_16x16x32_bf16 v[168:171], v[96:99], v[24:27], v[168:171]
    v_mfma_f32_16x16x32_bf16 v[200:203], v[100:103], v[24:27], v[200:203]
    buffer_load_dwordx4 v[40:43], v251, s[56:59], s19 offen
    s_add_u32 s19, s19, 7168
    buffer_load_dwordx4 v[44:47], v251, s[56:59], s19 offen
    s_add_u32 s19, s19, 7168
    buffer_load_dwordx4 v[48:51], v251, s[56:59], s19 offen
    s_add_u32 s19, s19, 7168
    buffer_load_dwordx4 v[52:55], v251, s[56:59], s19 offen
    s_add_u32 s19, s19, 7168
    buffer_load_dwordx4 v[232:235], v251, s[56:59], s19 offen
    s_add_u32 s19, s19, 7168
    buffer_load_dwordx4 v[236:239], v251, s[56:59], s19 offen
    s_add_u32 s19, s19, 7168
    buffer_load_dwordx4 v[240:243], v251, s[56:59], s19 offen
    s_add_u32 s19, s19, 7168
    buffer_load_dwordx4 v[244:247], v251, s[56:59], s19 offen
    ds_read_b64_tr_b16 v[24:25], v12 offset:40960
    ds_read_b64_tr_b16 v[26:27], v12 offset:45056
    s_waitcnt lgkmcnt(6)
    v_mfma_f32_16x16x32_bf16 v[172:175], v[96:99], v[28:31], v[172:175]
    v_mfma_f32_16x16x32_bf16 v[204:207], v[100:103], v[28:31], v[204:207]
    buffer_load_dwordx4 v[128:131], v250, s[52:55], s14 offen offset:2048
    buffer_load_dwordx4 v[132:135], v250, s[52:55], s14 offen offset:3072
    s_add_u32 s14, s14, 4096
    ds_read_b64_tr_b16 v[28:29], v13 offset:40960
    ds_read_b64_tr_b16 v[30:31], v13 offset:45056
    s_waitcnt lgkmcnt(6)
    v_mfma_f32_16x16x32_bf16 v[176:179], v[96:99], v[32:35], v[176:179]
    v_mfma_f32_16x16x32_bf16 v[208:211], v[100:103], v[32:35], v[208:211]
    ds_read_b64_tr_b16 v[32:33], v14 offset:40960
    ds_read_b64_tr_b16 v[34:35], v14 offset:45056
    s_waitcnt lgkmcnt(6)
    v_mfma_f32_16x16x32_bf16 v[180:183], v[96:99], v[36:39], v[180:183]
    v_mfma_f32_16x16x32_bf16 v[212:215], v[100:103], v[36:39], v[212:215]
    buffer_load_dwordx4 v[88:91], v250, s[64:67], s22 offen offset:0
    ds_read_b64_tr_b16 v[36:37], v15 offset:40960
    ds_read_b64_tr_b16 v[38:39], v15 offset:45056
    s_waitcnt lgkmcnt(6)
    v_mfma_f32_16x16x32_bf16 v[184:187], v[96:99], v[24:27], v[184:187]
    v_mfma_f32_16x16x32_bf16 v[216:219], v[100:103], v[24:27], v[216:219]
    ds_read_b64_tr_b16 v[24:25], v8 offset:49152
    ds_read_b64_tr_b16 v[26:27], v8 offset:53248
    s_waitcnt lgkmcnt(6)
    v_mfma_f32_16x16x32_bf16 v[188:191], v[96:99], v[28:31], v[188:191]
    v_mfma_f32_16x16x32_bf16 v[220:223], v[100:103], v[28:31], v[220:223]
    buffer_load_dwordx4 v[92:95], v250, s[64:67], s22 offen offset:1024
    ds_read_b64_tr_b16 v[28:29], v9 offset:49152
    ds_read_b64_tr_b16 v[30:31], v9 offset:53248
    s_waitcnt lgkmcnt(6)
    v_mfma_f32_16x16x32_bf16 v[192:195], v[96:99], v[32:35], v[192:195]
    v_mfma_f32_16x16x32_bf16 v[224:227], v[100:103], v[32:35], v[224:227]
    ds_read_b64_tr_b16 v[32:33], v10 offset:49152
    ds_read_b64_tr_b16 v[34:35], v10 offset:53248
    s_waitcnt lgkmcnt(6)
    v_mfma_f32_16x16x32_bf16 v[196:199], v[96:99], v[36:39], v[196:199]
    v_mfma_f32_16x16x32_bf16 v[228:231], v[100:103], v[36:39], v[228:231]
    ds_read_b64_tr_b16 v[36:37], v11 offset:49152
    ds_read_b64_tr_b16 v[38:39], v11 offset:53248
    s_waitcnt vmcnt(23) lgkmcnt(6)
    v_mfma_f32_16x16x32_bf16 v[168:171], v[104:107], v[24:27], v[168:171]
    v_mfma_f32_16x16x32_bf16 v[200:203], v[108:111], v[24:27], v[200:203]
    ds_read_b64_tr_b16 v[24:25], v12 offset:49152
    ds_read_b64_tr_b16 v[26:27], v12 offset:53248
    s_waitcnt lgkmcnt(6)
    v_mfma_f32_16x16x32_bf16 v[172:175], v[104:107], v[28:31], v[172:175]
    v_mfma_f32_16x16x32_bf16 v[204:207], v[108:111], v[28:31], v[204:207]
    buffer_load_dwordx4 v[136:139], v250, s[52:55], s14 offen offset:0
    buffer_load_dwordx4 v[140:143], v250, s[52:55], s14 offen offset:1024
    ds_read_b64_tr_b16 v[28:29], v13 offset:49152
    ds_read_b64_tr_b16 v[30:31], v13 offset:53248
    s_waitcnt lgkmcnt(6)
    v_mfma_f32_16x16x32_bf16 v[176:179], v[104:107], v[32:35], v[176:179]
    v_mfma_f32_16x16x32_bf16 v[208:211], v[108:111], v[32:35], v[208:211]
    ds_read_b64_tr_b16 v[32:33], v14 offset:49152
    ds_read_b64_tr_b16 v[34:35], v14 offset:53248
    s_waitcnt lgkmcnt(6)
    v_mfma_f32_16x16x32_bf16 v[180:183], v[104:107], v[36:39], v[180:183]
    v_mfma_f32_16x16x32_bf16 v[212:215], v[108:111], v[36:39], v[212:215]
    buffer_load_dwordx4 v[96:99], v250, s[64:67], s22 offen offset:2048
    ds_read_b64_tr_b16 v[36:37], v15 offset:49152
    ds_read_b64_tr_b16 v[38:39], v15 offset:53248
    s_waitcnt lgkmcnt(6)
    v_mfma_f32_16x16x32_bf16 v[184:187], v[104:107], v[24:27], v[184:187]
    v_mfma_f32_16x16x32_bf16 v[216:219], v[108:111], v[24:27], v[216:219]
    ds_read_b64_tr_b16 v[24:25], v8 offset:57344
    ds_read_b64_tr_b16 v[26:27], v8 offset:61440
    s_waitcnt lgkmcnt(6)
    v_mfma_f32_16x16x32_bf16 v[188:191], v[104:107], v[28:31], v[188:191]
    v_mfma_f32_16x16x32_bf16 v[220:223], v[108:111], v[28:31], v[220:223]
    buffer_load_dwordx4 v[100:103], v250, s[64:67], s22 offen offset:3072
    s_add_u32 s22, s22, 4096
    ds_read_b64_tr_b16 v[28:29], v9 offset:57344
    ds_read_b64_tr_b16 v[30:31], v9 offset:61440
    s_waitcnt lgkmcnt(6)
    v_mfma_f32_16x16x32_bf16 v[192:195], v[104:107], v[32:35], v[192:195]
    v_mfma_f32_16x16x32_bf16 v[224:227], v[108:111], v[32:35], v[224:227]
    ds_read_b64_tr_b16 v[32:33], v10 offset:57344
    ds_read_b64_tr_b16 v[34:35], v10 offset:61440
    s_waitcnt lgkmcnt(6)
    v_mfma_f32_16x16x32_bf16 v[196:199], v[104:107], v[36:39], v[196:199]
    v_mfma_f32_16x16x32_bf16 v[228:231], v[108:111], v[36:39], v[228:231]
    ds_read_b64_tr_b16 v[36:37], v11 offset:57344
    ds_read_b64_tr_b16 v[38:39], v11 offset:61440
    s_waitcnt vmcnt(22) lgkmcnt(6)
    v_mfma_f32_16x16x32_bf16 v[168:171], v[112:115], v[24:27], v[168:171]
    v_mfma_f32_16x16x32_bf16 v[200:203], v[116:119], v[24:27], v[200:203]
    ds_read_b64_tr_b16 v[24:25], v12 offset:57344
    ds_read_b64_tr_b16 v[26:27], v12 offset:61440
    s_waitcnt lgkmcnt(6)
    v_mfma_f32_16x16x32_bf16 v[172:175], v[112:115], v[28:31], v[172:175]
    v_mfma_f32_16x16x32_bf16 v[204:207], v[116:119], v[28:31], v[204:207]
    buffer_load_dwordx4 v[144:147], v250, s[52:55], s14 offen offset:2048
    buffer_load_dwordx4 v[148:151], v250, s[52:55], s14 offen offset:3072
    s_add_u32 s14, s14, 4096
    ds_read_b64_tr_b16 v[28:29], v13 offset:57344
    ds_read_b64_tr_b16 v[30:31], v13 offset:61440
    s_waitcnt lgkmcnt(6)
    v_mfma_f32_16x16x32_bf16 v[176:179], v[112:115], v[32:35], v[176:179]
    v_mfma_f32_16x16x32_bf16 v[208:211], v[116:119], v[32:35], v[208:211]
    ds_read_b64_tr_b16 v[32:33], v14 offset:57344
    ds_read_b64_tr_b16 v[34:35], v14 offset:61440
    s_waitcnt lgkmcnt(6)
    v_mfma_f32_16x16x32_bf16 v[180:183], v[112:115], v[36:39], v[180:183]
    v_mfma_f32_16x16x32_bf16 v[212:215], v[116:119], v[36:39], v[212:215]
    buffer_load_dwordx4 v[104:107], v250, s[64:67], s22 offen offset:0
    ds_read_b64_tr_b16 v[36:37], v15 offset:57344
    ds_read_b64_tr_b16 v[38:39], v15 offset:61440
    s_waitcnt lgkmcnt(6)
    v_mfma_f32_16x16x32_bf16 v[184:187], v[112:115], v[24:27], v[184:187]
    v_mfma_f32_16x16x32_bf16 v[216:219], v[116:119], v[24:27], v[216:219]
    ds_read_b64_tr_b16 v[24:25], v16 offset:0
    ds_read_b64_tr_b16 v[26:27], v16 offset:4096
    s_waitcnt lgkmcnt(6)
    v_mfma_f32_16x16x32_bf16 v[188:191], v[112:115], v[28:31], v[188:191]
    v_mfma_f32_16x16x32_bf16 v[220:223], v[116:119], v[28:31], v[220:223]
    buffer_load_dwordx4 v[108:111], v250, s[64:67], s22 offen offset:1024
    ds_read_b64_tr_b16 v[28:29], v17 offset:0
    ds_read_b64_tr_b16 v[30:31], v17 offset:4096
    s_waitcnt lgkmcnt(6)
    v_mfma_f32_16x16x32_bf16 v[192:195], v[112:115], v[32:35], v[192:195]
    v_mfma_f32_16x16x32_bf16 v[224:227], v[116:119], v[32:35], v[224:227]
    ds_read_b64_tr_b16 v[32:33], v18 offset:0
    ds_read_b64_tr_b16 v[34:35], v18 offset:4096
    s_waitcnt lgkmcnt(6)
    v_mfma_f32_16x16x32_bf16 v[196:199], v[112:115], v[36:39], v[196:199]
    v_mfma_f32_16x16x32_bf16 v[228:231], v[116:119], v[36:39], v[228:231]
    ds_read_b64_tr_b16 v[36:37], v19 offset:0
    ds_read_b64_tr_b16 v[38:39], v19 offset:4096
    s_waitcnt vmcnt(22) lgkmcnt(6)
    v_mfma_f32_16x16x32_bf16 v[168:171], v[120:123], v[24:27], v[168:171]
    v_mfma_f32_16x16x32_bf16 v[200:203], v[124:127], v[24:27], v[200:203]
    ds_read_b64_tr_b16 v[24:25], v20 offset:0
    ds_read_b64_tr_b16 v[26:27], v20 offset:4096
    s_waitcnt lgkmcnt(6)
    v_mfma_f32_16x16x32_bf16 v[172:175], v[120:123], v[28:31], v[172:175]
    v_mfma_f32_16x16x32_bf16 v[204:207], v[124:127], v[28:31], v[204:207]
    buffer_load_dwordx4 v[152:155], v250, s[52:55], s14 offen offset:0
    buffer_load_dwordx4 v[156:159], v250, s[52:55], s14 offen offset:1024
    ds_read_b64_tr_b16 v[28:29], v21 offset:0
    ds_read_b64_tr_b16 v[30:31], v21 offset:4096
    s_waitcnt lgkmcnt(6)
    v_mfma_f32_16x16x32_bf16 v[176:179], v[120:123], v[32:35], v[176:179]
    v_mfma_f32_16x16x32_bf16 v[208:211], v[124:127], v[32:35], v[208:211]
    ds_read_b64_tr_b16 v[32:33], v22 offset:0
    ds_read_b64_tr_b16 v[34:35], v22 offset:4096
    s_waitcnt lgkmcnt(6)
    v_mfma_f32_16x16x32_bf16 v[180:183], v[120:123], v[36:39], v[180:183]
    v_mfma_f32_16x16x32_bf16 v[212:215], v[124:127], v[36:39], v[212:215]
    buffer_load_dwordx4 v[112:115], v250, s[64:67], s22 offen offset:2048
    ds_read_b64_tr_b16 v[36:37], v23 offset:0
    ds_read_b64_tr_b16 v[38:39], v23 offset:4096
    s_waitcnt lgkmcnt(6)
    v_mfma_f32_16x16x32_bf16 v[184:187], v[120:123], v[24:27], v[184:187]
    v_mfma_f32_16x16x32_bf16 v[216:219], v[124:127], v[24:27], v[216:219]
    ds_read_b64_tr_b16 v[24:25], v16 offset:8192
    ds_read_b64_tr_b16 v[26:27], v16 offset:12288
    s_waitcnt lgkmcnt(6)
    v_mfma_f32_16x16x32_bf16 v[188:191], v[120:123], v[28:31], v[188:191]
    v_mfma_f32_16x16x32_bf16 v[220:223], v[124:127], v[28:31], v[220:223]
    buffer_load_dwordx4 v[116:119], v250, s[64:67], s22 offen offset:3072
    s_add_u32 s22, s22, 4096
    ds_read_b64_tr_b16 v[28:29], v17 offset:8192
    ds_read_b64_tr_b16 v[30:31], v17 offset:12288
    s_waitcnt lgkmcnt(6)
    v_mfma_f32_16x16x32_bf16 v[192:195], v[120:123], v[32:35], v[192:195]
    v_mfma_f32_16x16x32_bf16 v[224:227], v[124:127], v[32:35], v[224:227]
    ds_read_b64_tr_b16 v[32:33], v18 offset:8192
    ds_read_b64_tr_b16 v[34:35], v18 offset:12288
    s_waitcnt lgkmcnt(6)
    v_mfma_f32_16x16x32_bf16 v[196:199], v[120:123], v[36:39], v[196:199]
    v_mfma_f32_16x16x32_bf16 v[228:231], v[124:127], v[36:39], v[228:231]
    ds_read_b64_tr_b16 v[36:37], v19 offset:8192
    ds_read_b64_tr_b16 v[38:39], v19 offset:12288
    s_waitcnt vmcnt(14) lgkmcnt(6)
    v_mfma_f32_16x16x32_bf16 v[168:171], v[128:131], v[24:27], v[168:171]
    v_mfma_f32_16x16x32_bf16 v[200:203], v[132:135], v[24:27], v[200:203]
    ds_read_b64_tr_b16 v[24:25], v20 offset:8192
    ds_read_b64_tr_b16 v[26:27], v20 offset:12288
    s_waitcnt lgkmcnt(6)
    v_mfma_f32_16x16x32_bf16 v[172:175], v[128:131], v[28:31], v[172:175]
    v_mfma_f32_16x16x32_bf16 v[204:207], v[132:135], v[28:31], v[204:207]
    buffer_load_dwordx4 v[160:163], v250, s[52:55], s14 offen offset:2048
    buffer_load_dwordx4 v[164:167], v250, s[52:55], s14 offen offset:3072
    s_add_u32 s14, s14, 4096
    ds_read_b64_tr_b16 v[28:29], v21 offset:8192
    ds_read_b64_tr_b16 v[30:31], v21 offset:12288
    s_waitcnt lgkmcnt(6)
    v_mfma_f32_16x16x32_bf16 v[176:179], v[128:131], v[32:35], v[176:179]
    v_mfma_f32_16x16x32_bf16 v[208:211], v[132:135], v[32:35], v[208:211]
    ds_read_b64_tr_b16 v[32:33], v22 offset:8192
    ds_read_b64_tr_b16 v[34:35], v22 offset:12288
    s_waitcnt lgkmcnt(6)
    v_mfma_f32_16x16x32_bf16 v[180:183], v[128:131], v[36:39], v[180:183]
    v_mfma_f32_16x16x32_bf16 v[212:215], v[132:135], v[36:39], v[212:215]
    buffer_load_dwordx4 v[120:123], v250, s[64:67], s22 offen offset:0
    ds_read_b64_tr_b16 v[36:37], v23 offset:8192
    ds_read_b64_tr_b16 v[38:39], v23 offset:12288
    s_waitcnt lgkmcnt(6)
    v_mfma_f32_16x16x32_bf16 v[184:187], v[128:131], v[24:27], v[184:187]
    v_mfma_f32_16x16x32_bf16 v[216:219], v[132:135], v[24:27], v[216:219]
    ds_read_b64_tr_b16 v[24:25], v16 offset:16384
    ds_read_b64_tr_b16 v[26:27], v16 offset:20480
    s_waitcnt lgkmcnt(6)
    v_mfma_f32_16x16x32_bf16 v[188:191], v[128:131], v[28:31], v[188:191]
    v_mfma_f32_16x16x32_bf16 v[220:223], v[132:135], v[28:31], v[220:223]
    buffer_load_dwordx4 v[124:127], v250, s[64:67], s22 offen offset:1024
    ds_read_b64_tr_b16 v[28:29], v17 offset:16384
    ds_read_b64_tr_b16 v[30:31], v17 offset:20480
    s_waitcnt lgkmcnt(6)
    v_mfma_f32_16x16x32_bf16 v[192:195], v[128:131], v[32:35], v[192:195]
    v_mfma_f32_16x16x32_bf16 v[224:227], v[132:135], v[32:35], v[224:227]
    ds_read_b64_tr_b16 v[32:33], v18 offset:16384
    ds_read_b64_tr_b16 v[34:35], v18 offset:20480
    s_waitcnt lgkmcnt(6)
    v_mfma_f32_16x16x32_bf16 v[196:199], v[128:131], v[36:39], v[196:199]
    v_mfma_f32_16x16x32_bf16 v[228:231], v[132:135], v[36:39], v[228:231]
    ds_read_b64_tr_b16 v[36:37], v19 offset:16384
    ds_read_b64_tr_b16 v[38:39], v19 offset:20480
    s_waitcnt vmcnt(14) lgkmcnt(6)
    v_mfma_f32_16x16x32_bf16 v[168:171], v[136:139], v[24:27], v[168:171]
    v_mfma_f32_16x16x32_bf16 v[200:203], v[140:143], v[24:27], v[200:203]
    ds_read_b64_tr_b16 v[24:25], v20 offset:16384
    ds_read_b64_tr_b16 v[26:27], v20 offset:20480
    s_waitcnt lgkmcnt(6)
    v_mfma_f32_16x16x32_bf16 v[172:175], v[136:139], v[28:31], v[172:175]
    v_mfma_f32_16x16x32_bf16 v[204:207], v[140:143], v[28:31], v[204:207]
    ds_read_b64_tr_b16 v[28:29], v21 offset:16384
    ds_read_b64_tr_b16 v[30:31], v21 offset:20480
    s_waitcnt lgkmcnt(6)
    v_mfma_f32_16x16x32_bf16 v[176:179], v[136:139], v[32:35], v[176:179]
    v_mfma_f32_16x16x32_bf16 v[208:211], v[140:143], v[32:35], v[208:211]
    ds_read_b64_tr_b16 v[32:33], v22 offset:16384
    ds_read_b64_tr_b16 v[34:35], v22 offset:20480
    s_waitcnt lgkmcnt(6)
    v_mfma_f32_16x16x32_bf16 v[180:183], v[136:139], v[36:39], v[180:183]
    v_mfma_f32_16x16x32_bf16 v[212:215], v[140:143], v[36:39], v[212:215]
    buffer_load_dwordx4 v[128:131], v250, s[64:67], s22 offen offset:2048
    ds_read_b64_tr_b16 v[36:37], v23 offset:16384
    ds_read_b64_tr_b16 v[38:39], v23 offset:20480
    s_waitcnt lgkmcnt(6)
    v_mfma_f32_16x16x32_bf16 v[184:187], v[136:139], v[24:27], v[184:187]
    v_mfma_f32_16x16x32_bf16 v[216:219], v[140:143], v[24:27], v[216:219]
    ds_read_b64_tr_b16 v[24:25], v16 offset:24576
    ds_read_b64_tr_b16 v[26:27], v16 offset:28672
    s_waitcnt lgkmcnt(6)
    v_mfma_f32_16x16x32_bf16 v[188:191], v[136:139], v[28:31], v[188:191]
    v_mfma_f32_16x16x32_bf16 v[220:223], v[140:143], v[28:31], v[220:223]
    buffer_load_dwordx4 v[132:135], v250, s[64:67], s22 offen offset:3072
    s_add_u32 s22, s22, 4096
    ds_read_b64_tr_b16 v[28:29], v17 offset:24576
    ds_read_b64_tr_b16 v[30:31], v17 offset:28672
    s_waitcnt lgkmcnt(6)
    v_mfma_f32_16x16x32_bf16 v[192:195], v[136:139], v[32:35], v[192:195]
    v_mfma_f32_16x16x32_bf16 v[224:227], v[140:143], v[32:35], v[224:227]
    ds_read_b64_tr_b16 v[32:33], v18 offset:24576
    ds_read_b64_tr_b16 v[34:35], v18 offset:28672
    s_waitcnt lgkmcnt(6)
    v_mfma_f32_16x16x32_bf16 v[196:199], v[136:139], v[36:39], v[196:199]
    v_mfma_f32_16x16x32_bf16 v[228:231], v[140:143], v[36:39], v[228:231]
    ds_read_b64_tr_b16 v[36:37], v19 offset:24576
    ds_read_b64_tr_b16 v[38:39], v19 offset:28672
    s_waitcnt vmcnt(12) lgkmcnt(6)
    v_mfma_f32_16x16x32_bf16 v[168:171], v[144:147], v[24:27], v[168:171]
    v_mfma_f32_16x16x32_bf16 v[200:203], v[148:151], v[24:27], v[200:203]
    ds_read_b64_tr_b16 v[24:25], v20 offset:24576
    ds_read_b64_tr_b16 v[26:27], v20 offset:28672
    s_waitcnt lgkmcnt(6)
    v_mfma_f32_16x16x32_bf16 v[172:175], v[144:147], v[28:31], v[172:175]
    v_mfma_f32_16x16x32_bf16 v[204:207], v[148:151], v[28:31], v[204:207]
    ds_read_b64_tr_b16 v[28:29], v21 offset:24576
    ds_read_b64_tr_b16 v[30:31], v21 offset:28672
    s_waitcnt lgkmcnt(6)
    v_mfma_f32_16x16x32_bf16 v[176:179], v[144:147], v[32:35], v[176:179]
    v_mfma_f32_16x16x32_bf16 v[208:211], v[148:151], v[32:35], v[208:211]
    ds_read_b64_tr_b16 v[32:33], v22 offset:24576
    ds_read_b64_tr_b16 v[34:35], v22 offset:28672
    s_waitcnt lgkmcnt(6)
    v_mfma_f32_16x16x32_bf16 v[180:183], v[144:147], v[36:39], v[180:183]
    v_mfma_f32_16x16x32_bf16 v[212:215], v[148:151], v[36:39], v[212:215]
    buffer_load_dwordx4 v[136:139], v250, s[64:67], s22 offen offset:0
    ds_read_b64_tr_b16 v[36:37], v23 offset:24576
    ds_read_b64_tr_b16 v[38:39], v23 offset:28672
    s_waitcnt lgkmcnt(6)
    v_mfma_f32_16x16x32_bf16 v[184:187], v[144:147], v[24:27], v[184:187]
    v_mfma_f32_16x16x32_bf16 v[216:219], v[148:151], v[24:27], v[216:219]
    ds_read_b64_tr_b16 v[24:25], v16 offset:32768
    ds_read_b64_tr_b16 v[26:27], v16 offset:36864
    s_waitcnt lgkmcnt(6)
    v_mfma_f32_16x16x32_bf16 v[188:191], v[144:147], v[28:31], v[188:191]
    v_mfma_f32_16x16x32_bf16 v[220:223], v[148:151], v[28:31], v[220:223]
    buffer_load_dwordx4 v[140:143], v250, s[64:67], s22 offen offset:1024
    ds_read_b64_tr_b16 v[28:29], v17 offset:32768
    ds_read_b64_tr_b16 v[30:31], v17 offset:36864
    s_waitcnt lgkmcnt(6)
    v_mfma_f32_16x16x32_bf16 v[192:195], v[144:147], v[32:35], v[192:195]
    v_mfma_f32_16x16x32_bf16 v[224:227], v[148:151], v[32:35], v[224:227]
    ds_read_b64_tr_b16 v[32:33], v18 offset:32768
    ds_read_b64_tr_b16 v[34:35], v18 offset:36864
    s_waitcnt lgkmcnt(6)
    v_mfma_f32_16x16x32_bf16 v[196:199], v[144:147], v[36:39], v[196:199]
    v_mfma_f32_16x16x32_bf16 v[228:231], v[148:151], v[36:39], v[228:231]
    ds_read_b64_tr_b16 v[36:37], v19 offset:32768
    ds_read_b64_tr_b16 v[38:39], v19 offset:36864
    s_waitcnt vmcnt(10) lgkmcnt(6)
    v_mfma_f32_16x16x32_bf16 v[168:171], v[152:155], v[24:27], v[168:171]
    v_mfma_f32_16x16x32_bf16 v[200:203], v[156:159], v[24:27], v[200:203]
    ds_read_b64_tr_b16 v[24:25], v20 offset:32768
    ds_read_b64_tr_b16 v[26:27], v20 offset:36864
    s_waitcnt lgkmcnt(6)
    v_mfma_f32_16x16x32_bf16 v[172:175], v[152:155], v[28:31], v[172:175]
    v_mfma_f32_16x16x32_bf16 v[204:207], v[156:159], v[28:31], v[204:207]
    ds_read_b64_tr_b16 v[28:29], v21 offset:32768
    ds_read_b64_tr_b16 v[30:31], v21 offset:36864
    s_waitcnt lgkmcnt(6)
    v_mfma_f32_16x16x32_bf16 v[176:179], v[152:155], v[32:35], v[176:179]
    v_mfma_f32_16x16x32_bf16 v[208:211], v[156:159], v[32:35], v[208:211]
    ds_read_b64_tr_b16 v[32:33], v22 offset:32768
    ds_read_b64_tr_b16 v[34:35], v22 offset:36864
    s_waitcnt lgkmcnt(6)
    v_mfma_f32_16x16x32_bf16 v[180:183], v[152:155], v[36:39], v[180:183]
    v_mfma_f32_16x16x32_bf16 v[212:215], v[156:159], v[36:39], v[212:215]
    buffer_load_dwordx4 v[144:147], v250, s[64:67], s22 offen offset:2048
    ds_read_b64_tr_b16 v[36:37], v23 offset:32768
    ds_read_b64_tr_b16 v[38:39], v23 offset:36864
    s_waitcnt lgkmcnt(6)
    v_mfma_f32_16x16x32_bf16 v[184:187], v[152:155], v[24:27], v[184:187]
    v_mfma_f32_16x16x32_bf16 v[216:219], v[156:159], v[24:27], v[216:219]
    ds_read_b64_tr_b16 v[24:25], v16 offset:40960
    ds_read_b64_tr_b16 v[26:27], v16 offset:45056
    s_waitcnt lgkmcnt(6)
    v_mfma_f32_16x16x32_bf16 v[188:191], v[152:155], v[28:31], v[188:191]
    v_mfma_f32_16x16x32_bf16 v[220:223], v[156:159], v[28:31], v[220:223]
    buffer_load_dwordx4 v[148:151], v250, s[64:67], s22 offen offset:3072
    s_add_u32 s22, s22, 4096
    ds_read_b64_tr_b16 v[28:29], v17 offset:40960
    ds_read_b64_tr_b16 v[30:31], v17 offset:45056
    s_waitcnt lgkmcnt(6)
    v_mfma_f32_16x16x32_bf16 v[192:195], v[152:155], v[32:35], v[192:195]
    v_mfma_f32_16x16x32_bf16 v[224:227], v[156:159], v[32:35], v[224:227]
    ds_read_b64_tr_b16 v[32:33], v18 offset:40960
    ds_read_b64_tr_b16 v[34:35], v18 offset:45056
    s_waitcnt lgkmcnt(6)
    v_mfma_f32_16x16x32_bf16 v[196:199], v[152:155], v[36:39], v[196:199]
    v_mfma_f32_16x16x32_bf16 v[228:231], v[156:159], v[36:39], v[228:231]
    ds_read_b64_tr_b16 v[36:37], v19 offset:40960
    ds_read_b64_tr_b16 v[38:39], v19 offset:45056
    s_waitcnt vmcnt(8) lgkmcnt(6)
    v_mfma_f32_16x16x32_bf16 v[168:171], v[160:163], v[24:27], v[168:171]
    v_mfma_f32_16x16x32_bf16 v[200:203], v[164:167], v[24:27], v[200:203]
    ds_read_b64_tr_b16 v[24:25], v20 offset:40960
    ds_read_b64_tr_b16 v[26:27], v20 offset:45056
    s_waitcnt lgkmcnt(6)
    v_mfma_f32_16x16x32_bf16 v[172:175], v[160:163], v[28:31], v[172:175]
    v_mfma_f32_16x16x32_bf16 v[204:207], v[164:167], v[28:31], v[204:207]
    ds_read_b64_tr_b16 v[28:29], v21 offset:40960
    ds_read_b64_tr_b16 v[30:31], v21 offset:45056
    s_waitcnt lgkmcnt(6)
    v_mfma_f32_16x16x32_bf16 v[176:179], v[160:163], v[32:35], v[176:179]
    v_mfma_f32_16x16x32_bf16 v[208:211], v[164:167], v[32:35], v[208:211]
    ds_read_b64_tr_b16 v[32:33], v22 offset:40960
    ds_read_b64_tr_b16 v[34:35], v22 offset:45056
    s_waitcnt lgkmcnt(6)
    v_mfma_f32_16x16x32_bf16 v[180:183], v[160:163], v[36:39], v[180:183]
    v_mfma_f32_16x16x32_bf16 v[212:215], v[164:167], v[36:39], v[212:215]
    buffer_load_dwordx4 v[152:155], v250, s[64:67], s22 offen offset:0
    ds_read_b64_tr_b16 v[36:37], v23 offset:40960
    ds_read_b64_tr_b16 v[38:39], v23 offset:45056
    s_waitcnt lgkmcnt(6)
    v_mfma_f32_16x16x32_bf16 v[184:187], v[160:163], v[24:27], v[184:187]
    v_mfma_f32_16x16x32_bf16 v[216:219], v[164:167], v[24:27], v[216:219]
    s_waitcnt lgkmcnt(4)
    v_mfma_f32_16x16x32_bf16 v[188:191], v[160:163], v[28:31], v[188:191]
    v_mfma_f32_16x16x32_bf16 v[220:223], v[164:167], v[28:31], v[220:223]
    buffer_load_dwordx4 v[156:159], v250, s[64:67], s22 offen offset:1024
    s_waitcnt lgkmcnt(2)
    v_mfma_f32_16x16x32_bf16 v[192:195], v[160:163], v[32:35], v[192:195]
    v_mfma_f32_16x16x32_bf16 v[224:227], v[164:167], v[32:35], v[224:227]
    s_waitcnt lgkmcnt(0)
    v_mfma_f32_16x16x32_bf16 v[196:199], v[160:163], v[36:39], v[196:199]
    v_mfma_f32_16x16x32_bf16 v[228:231], v[164:167], v[36:39], v[228:231]
    v_pk_add_f32 v[40:41], v[40:41], v[232:233]
    v_pk_add_f32 v[42:43], v[42:43], v[234:235]
    v_pk_add_f32 v[44:45], v[44:45], v[236:237]
    v_pk_add_f32 v[46:47], v[46:47], v[238:239]
    v_pk_add_f32 v[48:49], v[48:49], v[240:241]
    v_pk_add_f32 v[50:51], v[50:51], v[242:243]
    v_pk_add_f32 v[52:53], v[52:53], v[244:245]
    v_pk_add_f32 v[54:55], v[54:55], v[246:247]
    v_bfe_u32 v244, v1, 2, 2
    v_lshl_add_u32 v244, v3, 4, v244
    s_min_u32 s18, s17, 6
    s_lshl_b32 s18, s18, 6
    s_and_b32 s19, s4, 1
    s_lshl_b32 s20, s19, 3
    s_add_u32 s18, s18, s20
    v_add_u32 v244, s18, v244
    s_lshr_b32 s20, s4, 1
    s_lshl_b32 s21, s16, 2
    s_add_u32 s21, s21, s20
    v_bfe_u32 v245, v1, 2, 2
    v_xor_b32 v246, s21, v245
    v_xor_b32 v247, 4, v246
    v_and_b32 v245, 3, v1
    v_lshlrev_b32 v245, 3, v245
    v_lshl_add_u32 v245, v244, 8, v245
    v_lshl_add_u32 v246, v246, 5, v245
    v_lshl_add_u32 v247, v247, 5, v245
    ds_read_b64_tr_b16 v[232:233], v246
    ds_read_b64_tr_b16 v[234:235], v247 offset:1024
    s_mov_b32 s68, s46
    s_mov_b32 s69, s47
    s_mov_b32 s70, 0x2a00
    s_mov_b32 s71, 0x20000
    v_lshlrev_b32 v244, 6, v3
    s_lshl_b32 s23, s18, 2
    s_add_u32 s23, s23, 8960
    buffer_load_dwordx4 v[236:239], v244, s[68:71], s23 offen offset:0
    buffer_load_dwordx4 v[240:243], v244, s[68:71], s23 offen offset:16
    v_mov_b32 v5, 132096
    s_mov_b32 s78, 4194304
    s_nop 0
k34_stw:
    ds_read_b32 v2, v5
    s_waitcnt lgkmcnt(0)
    v_readfirstlane_b32 s79, v2
    s_nop 0
    s_cmp_lg_u32 s79, 0
    s_nop 2
    s_cbranch_scc1 k34_stw_done
    s_sub_u32 s78, s78, 1
    s_cmp_eq_u32 s78, 0
    s_cbranch_scc1 k34_stw_done
    s_sleep 2
    s_branch k34_stw
k34_stw_done:
    v_lshlrev_b32 v5, 3, v4
    v_add_u32 v5, 131072, v5
    ds_read_b64 v[8:9], v5 offset:0
    ds_read_b64 v[10:11], v5 offset:128
    ds_read_b64 v[12:13], v5 offset:256
    ds_read_b64 v[14:15], v5 offset:384
    ds_read_b64 v[16:17], v5 offset:512
    ds_read_b64 v[18:19], v5 offset:640
    ds_read_b64 v[20:21], v5 offset:768
    ds_read_b64 v[22:23], v5 offset:896
    s_mul_i32 s14, s7, 448
    s_lshr_b32 s15, s13, 1
    s_add_u32 s14, s14, s15
    s_lshl_b32 s14, s14, 10
    s_and_b32 s15, s13, 1
    s_lshl_b32 s15, s15, 9
    s_add_u32 s14, s14, s15
    v_and_b32 v248, 1, v3
    v_mul_u32_u24 v248, 57344, v248
    v_lshrrev_b32 v249, 1, v3
    v_lshl_add_u32 v248, v249, 8, v248
    v_lshl_add_u32 v248, v4, 4, v248
    v_mov_b32 v252, 0xbfb8aa3b
    v_mov_b32 v254, 1.0
    s_waitcnt lgkmcnt(7)
    v_mov_b32 v36, v9
    v_pk_fma_f32 v[24:25], v[40:41], v[36:37], v[44:45] op_sel_hi:[1,0,1] neg_lo:[0,1,0] neg_hi:[0,1,0]
    v_pk_fma_f32 v[28:29], v[48:49], v[36:37], v[52:53] op_sel_hi:[1,0,1] neg_lo:[0,1,0] neg_hi:[0,1,0]
    v_pk_fma_f32 v[26:27], v[42:43], v[36:37], v[46:47] op_sel_hi:[1,0,1] neg_lo:[0,1,0] neg_hi:[0,1,0]
    v_pk_fma_f32 v[30:31], v[50:51], v[36:37], v[54:55] op_sel_hi:[1,0,1] neg_lo:[0,1,0] neg_hi:[0,1,0]
    v_pk_fma_f32 v[24:25], v[168:169], v[8:9], v[24:25] op_sel_hi:[1,0,1]
    v_pk_fma_f32 v[28:29], v[200:201], v[8:9], v[28:29] op_sel_hi:[1,0,1]
    v_pk_fma_f32 v[26:27], v[170:171], v[8:9], v[26:27] op_sel_hi:[1,0,1]
    v_pk_fma_f32 v[30:31], v[202:203], v[8:9], v[30:31] op_sel_hi:[1,0,1]
    v_pk_mul_f32 v[32:33], v[24:25], v[252:253] op_sel_hi:[1,0]
    v_pk_mul_f32 v[34:35], v[26:27], v[252:253] op_sel_hi:[1,0]
    v_exp_f32 v32, v32
    v_exp_f32 v33, v33
    v_exp_f32 v34, v34
    v_exp_f32 v35, v35
    v_pk_mul_f32 v[24:25], v[24:25], v[28:29]
    v_pk_mul_f32 v[26:27], v[26:27], v[30:31]
    v_pk_add_f32 v[32:33], v[32:33], v[254:255] op_sel_hi:[1,0]
    v_pk_add_f32 v[34:35], v[34:35], v[254:255] op_sel_hi:[1,0]
    v_rcp_f32 v32, v32
    v_rcp_f32 v33, v33
    v_rcp_f32 v34, v34
    v_rcp_f32 v35, v35
    v_pk_mul_f32 v[24:25], v[24:25], v[32:33]
    v_pk_mul_f32 v[26:27], v[26:27], v[34:35]
    v_cvt_pk_bf16_f32 v168, v24, v25
    v_cvt_pk_bf16_f32 v169, v26, v27
    s_waitcnt lgkmcnt(6)
    v_mov_b32 v36, v11
    v_pk_fma_f32 v[24:25], v[40:41], v[36:37], v[44:45] op_sel_hi:[1,0,1] neg_lo:[0,1,0] neg_hi:[0,1,0]
    v_pk_fma_f32 v[28:29], v[48:49], v[36:37], v[52:53] op_sel_hi:[1,0,1] neg_lo:[0,1,0] neg_hi:[0,1,0]
    v_pk_fma_f32 v[26:27], v[42:43], v[36:37], v[46:47] op_sel_hi:[1,0,1] neg_lo:[0,1,0] neg_hi:[0,1,0]
    v_pk_fma_f32 v[30:31], v[50:51], v[36:37], v[54:55] op_sel_hi:[1,0,1] neg_lo:[0,1,0] neg_hi:[0,1,0]
    v_pk_fma_f32 v[24:25], v[172:173], v[10:11], v[24:25] op_sel_hi:[1,0,1]
    v_pk_fma_f32 v[28:29], v[204:205], v[10:11], v[28:29] op_sel_hi:[1,0,1]
    v_pk_fma_f32 v[26:27], v[174:175], v[10:11], v[26:27] op_sel_hi:[1,0,1]
    v_pk_fma_f32 v[30:31], v[206:207], v[10:11], v[30:31] op_sel_hi:[1,0,1]
    v_pk_mul_f32 v[32:33], v[24:25], v[252:253] op_sel_hi:[1,0]
    v_pk_mul_f32 v[34:35], v[26:27], v[252:253] op_sel_hi:[1,0]
    v_exp_f32 v32, v32
    v_exp_f32 v33, v33
    v_exp_f32 v34, v34
    v_exp_f32 v35, v35
    v_pk_mul_f32 v[24:25], v[24:25], v[28:29]
    v_pk_mul_f32 v[26:27], v[26:27], v[30:31]
    v_pk_add_f32 v[32:33], v[32:33], v[254:255] op_sel_hi:[1,0]
    v_pk_add_f32 v[34:35], v[34:35], v[254:255] op_sel_hi:[1,0]
    v_rcp_f32 v32, v32
    v_rcp_f32 v33, v33
    v_rcp_f32 v34, v34
    v_rcp_f32 v35, v35
    v_pk_mul_f32 v[24:25], v[24:25], v[32:33]
    v_pk_mul_f32 v[26:27], v[26:27], v[34:35]
    v_cvt_pk_bf16_f32 v170, v24, v25
    v_cvt_pk_bf16_f32 v171, v26, v27
    s_nop 0
    v_permlane16_swap_b32 v168, v170
    v_permlane16_swap_b32 v169, v171
    buffer_store_dwordx4 v[168:171], v248, s[60:63], s14 offen sc1
    s_add_u32 s14, s14, 114688
    s_waitcnt lgkmcnt(5)
    v_mov_b32 v36, v13
    v_pk_fma_f32 v[24:25], v[40:41], v[36:37], v[44:45] op_sel_hi:[1,0,1] neg_lo:[0,1,0] neg_hi:[0,1,0]
    v_pk_fma_f32 v[28:29], v[48:49], v[36:37], v[52:53] op_sel_hi:[1,0,1] neg_lo:[0,1,0] neg_hi:[0,1,0]
    v_pk_fma_f32 v[26:27], v[42:43], v[36:37], v[46:47] op_sel_hi:[1,0,1] neg_lo:[0,1,0] neg_hi:[0,1,0]
    v_pk_fma_f32 v[30:31], v[50:51], v[36:37], v[54:55] op_sel_hi:[1,0,1] neg_lo:[0,1,0] neg_hi:[0,1,0]
    v_pk_fma_f32 v[24:25], v[176:177], v[12:13], v[24:25] op_sel_hi:[1,0,1]
    v_pk_fma_f32 v[28:29], v[208:209], v[12:13], v[28:29] op_sel_hi:[1,0,1]
    v_pk_fma_f32 v[26:27], v[178:179], v[12:13], v[26:27] op_sel_hi:[1,0,1]
    v_pk_fma_f32 v[30:31], v[210:211], v[12:13], v[30:31] op_sel_hi:[1,0,1]
    v_pk_mul_f32 v[32:33], v[24:25], v[252:253] op_sel_hi:[1,0]
    v_pk_mul_f32 v[34:35], v[26:27], v[252:253] op_sel_hi:[1,0]
    v_exp_f32 v32, v32
    v_exp_f32 v33, v33
    v_exp_f32 v34, v34
    v_exp_f32 v35, v35
    v_pk_mul_f32 v[24:25], v[24:25], v[28:29]
    v_pk_mul_f32 v[26:27], v[26:27], v[30:31]
    v_pk_add_f32 v[32:33], v[32:33], v[254:255] op_sel_hi:[1,0]
    v_pk_add_f32 v[34:35], v[34:35], v[254:255] op_sel_hi:[1,0]
    v_rcp_f32 v32, v32
    v_rcp_f32 v33, v33
    v_rcp_f32 v34, v34
    v_rcp_f32 v35, v35
    v_pk_mul_f32 v[24:25], v[24:25], v[32:33]
    v_pk_mul_f32 v[26:27], v[26:27], v[34:35]
    v_cvt_pk_bf16_f32 v176, v24, v25
    v_cvt_pk_bf16_f32 v177, v26, v27
    s_waitcnt lgkmcnt(4)
    v_mov_b32 v36, v15
    v_pk_fma_f32 v[24:25], v[40:41], v[36:37], v[44:45] op_sel_hi:[1,0,1] neg_lo:[0,1,0] neg_hi:[0,1,0]
    v_pk_fma_f32 v[28:29], v[48:49], v[36:37], v[52:53] op_sel_hi:[1,0,1] neg_lo:[0,1,0] neg_hi:[0,1,0]
    v_pk_fma_f32 v[26:27], v[42:43], v[36:37], v[46:47] op_sel_hi:[1,0,1] neg_lo:[0,1,0] neg_hi:[0,1,0]
    v_pk_fma_f32 v[30:31], v[50:51], v[36:37], v[54:55] op_sel_hi:[1,0,1] neg_lo:[0,1,0] neg_hi:[0,1,0]
    v_pk_fma_f32 v[24:25], v[180:181], v[14:15], v[24:25] op_sel_hi:[1,0,1]
    v_pk_fma_f32 v[28:29], v[212:213], v[14:15], v[28:29] op_sel_hi:[1,0,1]
    v_pk_fma_f32 v[26:27], v[182:183], v[14:15], v[26:27] op_sel_hi:[1,0,1]
    v_pk_fma_f32 v[30:31], v[214:215], v[14:15], v[30:31] op_sel_hi:[1,0,1]
    v_pk_mul_f32 v[32:33], v[24:25], v[252:253] op_sel_hi:[1,0]
    v_pk_mul_f32 v[34:35], v[26:27], v[252:253] op_sel_hi:[1,0]
    v_exp_f32 v32, v32
    v_exp_f32 v33, v33
    v_exp_f32 v34, v34
    v_exp_f32 v35, v35
    v_pk_mul_f32 v[24:25], v[24:25], v[28:29]
    v_pk_mul_f32 v[26:27], v[26:27], v[30:31]
    v_pk_add_f32 v[32:33], v[32:33], v[254:255] op_sel_hi:[1,0]
    v_pk_add_f32 v[34:35], v[34:35], v[254:255] op_sel_hi:[1,0]
    v_rcp_f32 v32, v32
    v_rcp_f32 v33, v33
    v_rcp_f32 v34, v34
    v_rcp_f32 v35, v35
    v_pk_mul_f32 v[24:25], v[24:25], v[32:33]
    v_pk_mul_f32 v[26:27], v[26:27], v[34:35]
    v_cvt_pk_bf16_f32 v178, v24, v25
    v_cvt_pk_bf16_f32 v179, v26, v27
    s_nop 0
    v_permlane16_swap_b32 v176, v178
    v_permlane16_swap_b32 v177, v179
    buffer_store_dwordx4 v[176:179], v248, s[60:63], s14 offen sc1
    s_add_u32 s14, s14, 114688
    s_waitcnt lgkmcnt(3)
    v_mov_b32 v36, v17
    v_pk_fma_f32 v[24:25], v[40:41], v[36:37], v[44:45] op_sel_hi:[1,0,1] neg_lo:[0,1,0] neg_hi:[0,1,0]
    v_pk_fma_f32 v[28:29], v[48:49], v[36:37], v[52:53] op_sel_hi:[1,0,1] neg_lo:[0,1,0] neg_hi:[0,1,0]
    v_pk_fma_f32 v[26:27], v[42:43], v[36:37], v[46:47] op_sel_hi:[1,0,1] neg_lo:[0,1,0] neg_hi:[0,1,0]
    v_pk_fma_f32 v[30:31], v[50:51], v[36:37], v[54:55] op_sel_hi:[1,0,1] neg_lo:[0,1,0] neg_hi:[0,1,0]
    v_pk_fma_f32 v[24:25], v[184:185], v[16:17], v[24:25] op_sel_hi:[1,0,1]
    v_pk_fma_f32 v[28:29], v[216:217], v[16:17], v[28:29] op_sel_hi:[1,0,1]
    v_pk_fma_f32 v[26:27], v[186:187], v[16:17], v[26:27] op_sel_hi:[1,0,1]
    v_pk_fma_f32 v[30:31], v[218:219], v[16:17], v[30:31] op_sel_hi:[1,0,1]
    v_pk_mul_f32 v[32:33], v[24:25], v[252:253] op_sel_hi:[1,0]
    v_pk_mul_f32 v[34:35], v[26:27], v[252:253] op_sel_hi:[1,0]
    v_exp_f32 v32, v32
    v_exp_f32 v33, v33
    v_exp_f32 v34, v34
    v_exp_f32 v35, v35
    v_pk_mul_f32 v[24:25], v[24:25], v[28:29]
    v_pk_mul_f32 v[26:27], v[26:27], v[30:31]
    v_pk_add_f32 v[32:33], v[32:33], v[254:255] op_sel_hi:[1,0]
    v_pk_add_f32 v[34:35], v[34:35], v[254:255] op_sel_hi:[1,0]
    v_rcp_f32 v32, v32
    v_rcp_f32 v33, v33
    v_rcp_f32 v34, v34
    v_rcp_f32 v35, v35
    v_pk_mul_f32 v[24:25], v[24:25], v[32:33]
    v_pk_mul_f32 v[26:27], v[26:27], v[34:35]
    v_cvt_pk_bf16_f32 v184, v24, v25
    v_cvt_pk_bf16_f32 v185, v26, v27
    s_waitcnt lgkmcnt(2)
    v_mov_b32 v36, v19
    v_pk_fma_f32 v[24:25], v[40:41], v[36:37], v[44:45] op_sel_hi:[1,0,1] neg_lo:[0,1,0] neg_hi:[0,1,0]
    v_pk_fma_f32 v[28:29], v[48:49], v[36:37], v[52:53] op_sel_hi:[1,0,1] neg_lo:[0,1,0] neg_hi:[0,1,0]
    v_pk_fma_f32 v[26:27], v[42:43], v[36:37], v[46:47] op_sel_hi:[1,0,1] neg_lo:[0,1,0] neg_hi:[0,1,0]
    v_pk_fma_f32 v[30:31], v[50:51], v[36:37], v[54:55] op_sel_hi:[1,0,1] neg_lo:[0,1,0] neg_hi:[0,1,0]
    v_pk_fma_f32 v[24:25], v[188:189], v[18:19], v[24:25] op_sel_hi:[1,0,1]
    v_pk_fma_f32 v[28:29], v[220:221], v[18:19], v[28:29] op_sel_hi:[1,0,1]
    v_pk_fma_f32 v[26:27], v[190:191], v[18:19], v[26:27] op_sel_hi:[1,0,1]
    v_pk_fma_f32 v[30:31], v[222:223], v[18:19], v[30:31] op_sel_hi:[1,0,1]
    v_pk_mul_f32 v[32:33], v[24:25], v[252:253] op_sel_hi:[1,0]
    v_pk_mul_f32 v[34:35], v[26:27], v[252:253] op_sel_hi:[1,0]
    v_exp_f32 v32, v32
    v_exp_f32 v33, v33
    v_exp_f32 v34, v34
    v_exp_f32 v35, v35
    v_pk_mul_f32 v[24:25], v[24:25], v[28:29]
    v_pk_mul_f32 v[26:27], v[26:27], v[30:31]
    v_pk_add_f32 v[32:33], v[32:33], v[254:255] op_sel_hi:[1,0]
    v_pk_add_f32 v[34:35], v[34:35], v[254:255] op_sel_hi:[1,0]
    v_rcp_f32 v32, v32
    v_rcp_f32 v33, v33
    v_rcp_f32 v34, v34
    v_rcp_f32 v35, v35
    v_pk_mul_f32 v[24:25], v[24:25], v[32:33]
    v_pk_mul_f32 v[26:27], v[26:27], v[34:35]
    v_cvt_pk_bf16_f32 v186, v24, v25
    v_cvt_pk_bf16_f32 v187, v26, v27
    s_nop 0
    v_permlane16_swap_b32 v184, v186
    v_permlane16_swap_b32 v185, v187
    buffer_store_dwordx4 v[184:187], v248, s[60:63], s14 offen sc1
    s_add_u32 s14, s14, 114688
    s_waitcnt lgkmcnt(1)
    v_mov_b32 v36, v21
    v_pk_fma_f32 v[24:25], v[40:41], v[36:37], v[44:45] op_sel_hi:[1,0,1] neg_lo:[0,1,0] neg_hi:[0,1,0]
    v_pk_fma_f32 v[28:29], v[48:49], v[36:37], v[52:53] op_sel_hi:[1,0,1] neg_lo:[0,1,0] neg_hi:[0,1,0]
    v_pk_fma_f32 v[26:27], v[42:43], v[36:37], v[46:47] op_sel_hi:[1,0,1] neg_lo:[0,1,0] neg_hi:[0,1,0]
    v_pk_fma_f32 v[30:31], v[50:51], v[36:37], v[54:55] op_sel_hi:[1,0,1] neg_lo:[0,1,0] neg_hi:[0,1,0]
    v_pk_fma_f32 v[24:25], v[192:193], v[20:21], v[24:25] op_sel_hi:[1,0,1]
    v_pk_fma_f32 v[28:29], v[224:225], v[20:21], v[28:29] op_sel_hi:[1,0,1]
    v_pk_fma_f32 v[26:27], v[194:195], v[20:21], v[26:27] op_sel_hi:[1,0,1]
    v_pk_fma_f32 v[30:31], v[226:227], v[20:21], v[30:31] op_sel_hi:[1,0,1]
    v_pk_mul_f32 v[32:33], v[24:25], v[252:253] op_sel_hi:[1,0]
    v_pk_mul_f32 v[34:35], v[26:27], v[252:253] op_sel_hi:[1,0]
    v_exp_f32 v32, v32
    v_exp_f32 v33, v33
    v_exp_f32 v34, v34
    v_exp_f32 v35, v35
    v_pk_mul_f32 v[24:25], v[24:25], v[28:29]
    v_pk_mul_f32 v[26:27], v[26:27], v[30:31]
    v_pk_add_f32 v[32:33], v[32:33], v[254:255] op_sel_hi:[1,0]
    v_pk_add_f32 v[34:35], v[34:35], v[254:255] op_sel_hi:[1,0]
    v_rcp_f32 v32, v32
    v_rcp_f32 v33, v33
    v_rcp_f32 v34, v34
    v_rcp_f32 v35, v35
    v_pk_mul_f32 v[24:25], v[24:25], v[32:33]
    v_pk_mul_f32 v[26:27], v[26:27], v[34:35]
    v_cvt_pk_bf16_f32 v192, v24, v25
    v_cvt_pk_bf16_f32 v193, v26, v27
    s_waitcnt lgkmcnt(0)
    v_mov_b32 v36, v23
    v_pk_fma_f32 v[24:25], v[40:41], v[36:37], v[44:45] op_sel_hi:[1,0,1] neg_lo:[0,1,0] neg_hi:[0,1,0]
    v_pk_fma_f32 v[28:29], v[48:49], v[36:37], v[52:53] op_sel_hi:[1,0,1] neg_lo:[0,1,0] neg_hi:[0,1,0]
    v_pk_fma_f32 v[26:27], v[42:43], v[36:37], v[46:47] op_sel_hi:[1,0,1] neg_lo:[0,1,0] neg_hi:[0,1,0]
    v_pk_fma_f32 v[30:31], v[50:51], v[36:37], v[54:55] op_sel_hi:[1,0,1] neg_lo:[0,1,0] neg_hi:[0,1,0]
    v_pk_fma_f32 v[24:25], v[196:197], v[22:23], v[24:25] op_sel_hi:[1,0,1]
    v_pk_fma_f32 v[28:29], v[228:229], v[22:23], v[28:29] op_sel_hi:[1,0,1]
    v_pk_fma_f32 v[26:27], v[198:199], v[22:23], v[26:27] op_sel_hi:[1,0,1]
    v_pk_fma_f32 v[30:31], v[230:231], v[22:23], v[30:31] op_sel_hi:[1,0,1]
    v_pk_mul_f32 v[32:33], v[24:25], v[252:253] op_sel_hi:[1,0]
    v_pk_mul_f32 v[34:35], v[26:27], v[252:253] op_sel_hi:[1,0]
    v_exp_f32 v32, v32
    v_exp_f32 v33, v33
    v_exp_f32 v34, v34
    v_exp_f32 v35, v35
    v_pk_mul_f32 v[24:25], v[24:25], v[28:29]
    v_pk_mul_f32 v[26:27], v[26:27], v[30:31]
    v_pk_add_f32 v[32:33], v[32:33], v[254:255] op_sel_hi:[1,0]
    v_pk_add_f32 v[34:35], v[34:35], v[254:255] op_sel_hi:[1,0]
    v_rcp_f32 v32, v32
    v_rcp_f32 v33, v33
    v_rcp_f32 v34, v34
    v_rcp_f32 v35, v35
    v_pk_mul_f32 v[24:25], v[24:25], v[32:33]
    v_pk_mul_f32 v[26:27], v[26:27], v[34:35]
    v_cvt_pk_bf16_f32 v194, v24, v25
    v_cvt_pk_bf16_f32 v195, v26, v27
    s_nop 0
    v_permlane16_swap_b32 v192, v194
    v_permlane16_swap_b32 v193, v195
    buffer_store_dwordx4 v[192:195], v248, s[60:63], s14 offen sc1
    s_nop 1
    s_branch k34_sig
k34_stats:
    v_mov_b32 v40, 0x3f803f80
    v_mov_b32 v41, 0x3f803f80
    v_mov_b32 v42, 0x3f803f80
    v_mov_b32 v43, 0x3f803f80
    v_mov_b32 v2, 0
    v_mov_b32 v5, 132096
    ds_write_b32 v5, v2
    s_waitcnt vmcnt(0) lgkmcnt(0)
    s_barrier
    ds_read_b64_tr_b16 v[24:25], v8 offset:0
    ds_read_b64_tr_b16 v[26:27], v8 offset:4096
    ds_read_b64_tr_b16 v[28:29], v9 offset:0
    ds_read_b64_tr_b16 v[30:31], v9 offset:4096
    ds_read_b64_tr_b16 v[32:33], v10 offset:0
    ds_read_b64_tr_b16 v[34:35], v10 offset:4096
    ds_read_b64_tr_b16 v[36:37], v11 offset:0
    ds_read_b64_tr_b16 v[38:39], v11 offset:4096
    s_waitcnt lgkmcnt(6)
    v_mfma_f32_16x16x32_bf16 v[168:171], v[24:27], v[24:27], 0
    v_mfma_f32_16x16x32_bf16 v[200:203], v[40:43], v[24:27], 0
    s_mov_b32 m0, s12
    s_nop 0
    buffer_load_dwordx4 v6, s[48:51], s11 offen lds
    s_add_u32 s11, s11, 131072
    s_add_u32 s12, s12, 8192
    ds_read_b64_tr_b16 v[24:25], v12 offset:0
    ds_read_b64_tr_b16 v[26:27], v12 offset:4096
    s_waitcnt lgkmcnt(6)
    v_mfma_f32_16x16x32_bf16 v[172:175], v[28:31], v[28:31], 0
    v_mfma_f32_16x16x32_bf16 v[204:207], v[40:43], v[28:31], 0
    ds_read_b64_tr_b16 v[28:29], v13 offset:0
    ds_read_b64_tr_b16 v[30:31], v13 offset:4096
    s_waitcnt lgkmcnt(6)
    v_mfma_f32_16x16x32_bf16 v[176:179], v[32:35], v[32:35], 0
    v_mfma_f32_16x16x32_bf16 v[208:211], v[40:43], v[32:35], 0
    s_mov_b32 m0, s12
    s_nop 0
    buffer_load_dwordx4 v6, s[48:51], s11 offen lds
    s_add_u32 s11, s11, 131072
    s_add_u32 s12, s12, 8192
    ds_read_b64_tr_b16 v[32:33], v14 offset:0
    ds_read_b64_tr_b16 v[34:35], v14 offset:4096
    s_waitcnt lgkmcnt(6)
    v_mfma_f32_16x16x32_bf16 v[180:183], v[36:39], v[36:39], 0
    v_mfma_f32_16x16x32_bf16 v[212:215], v[40:43], v[36:39], 0
    ds_read_b64_tr_b16 v[36:37], v15 offset:0
    ds_read_b64_tr_b16 v[38:39], v15 offset:4096
    s_waitcnt lgkmcnt(6)
    v_mfma_f32_16x16x32_bf16 v[184:187], v[24:27], v[24:27], 0
    v_mfma_f32_16x16x32_bf16 v[216:219], v[40:43], v[24:27], 0
    s_mov_b32 m0, s12
    s_nop 0
    buffer_load_dwordx4 v6, s[48:51], s11 offen lds
    s_add_u32 s11, s11, 131072
    s_add_u32 s12, s12, 8192
    ds_read_b64_tr_b16 v[24:25], v8 offset:8192
    ds_read_b64_tr_b16 v[26:27], v8 offset:12288
    s_waitcnt lgkmcnt(6)
    v_mfma_f32_16x16x32_bf16 v[188:191], v[28:31], v[28:31], 0
    v_mfma_f32_16x16x32_bf16 v[220:223], v[40:43], v[28:31], 0
    ds_read_b64_tr_b16 v[28:29], v9 offset:8192
    ds_read_b64_tr_b16 v[30:31], v9 offset:12288
    s_waitcnt lgkmcnt(6)
    v_mfma_f32_16x16x32_bf16 v[192:195], v[32:35], v[32:35], 0
    v_mfma_f32_16x16x32_bf16 v[224:227], v[40:43], v[32:35], 0
    s_mov_b32 m0, s12
    s_nop 0
    buffer_load_dwordx4 v6, s[48:51], s11 offen lds
    s_add_u32 s11, s11, 131072
    s_add_u32 s12, s12, 8192
    ds_read_b64_tr_b16 v[32:33], v10 offset:8192
    ds_read_b64_tr_b16 v[34:35], v10 offset:12288
    s_waitcnt lgkmcnt(6)
    v_mfma_f32_16x16x32_bf16 v[196:199], v[36:39], v[36:39], 0
    v_mfma_f32_16x16x32_bf16 v[228:231], v[40:43], v[36:39], 0
    ds_read_b64_tr_b16 v[36:37], v11 offset:8192
    ds_read_b64_tr_b16 v[38:39], v11 offset:12288
    s_waitcnt lgkmcnt(6)
    v_mfma_f32_16x16x32_bf16 v[168:171], v[24:27], v[24:27], v[168:171]
    v_mfma_f32_16x16x32_bf16 v[200:203], v[40:43], v[24:27], v[200:203]
    s_mov_b32 m0, s12
    s_nop 0
    buffer_load_dwordx4 v6, s[48:51], s11 offen lds
    s_add_u32 s11, s11, 131072
    s_add_u32 s12, s12, 8192
    ds_read_b64_tr_b16 v[24:25], v12 offset:8192
    ds_read_b64_tr_b16 v[26:27], v12 offset:12288
    s_waitcnt lgkmcnt(6)
    v_mfma_f32_16x16x32_bf16 v[172:175], v[28:31], v[28:31], v[172:175]
    v_mfma_f32_16x16x32_bf16 v[204:207], v[40:43], v[28:31], v[204:207]
    ds_read_b64_tr_b16 v[28:29], v13 offset:8192
    ds_read_b64_tr_b16 v[30:31], v13 offset:12288
    s_waitcnt lgkmcnt(6)
    v_mfma_f32_16x16x32_bf16 v[176:179], v[32:35], v[32:35], v[176:179]
    v_mfma_f32_16x16x32_bf16 v[208:211], v[40:43], v[32:35], v[208:211]
    s_mov_b32 m0, s12
    s_nop 0
    buffer_load_dwordx4 v6, s[48:51], s11 offen lds
    s_add_u32 s11, s11, 131072
    s_add_u32 s12, s12, 8192
    ds_read_b64_tr_b16 v[32:33], v14 offset:8192
    ds_read_b64_tr_b16 v[34:35], v14 offset:12288
    s_waitcnt lgkmcnt(6)
    v_mfma_f32_16x16x32_bf16 v[180:183], v[36:39], v[36:39], v[180:183]
    v_mfma_f32_16x16x32_bf16 v[212:215], v[40:43], v[36:39], v[212:215]
    buffer_load_dwordx4 v[56:59], v250, s[64:67], s22 offen offset:0
    ds_read_b64_tr_b16 v[36:37], v15 offset:8192
    ds_read_b64_tr_b16 v[38:39], v15 offset:12288
    s_waitcnt lgkmcnt(6)
    v_mfma_f32_16x16x32_bf16 v[184:187], v[24:27], v[24:27], v[184:187]
    v_mfma_f32_16x16x32_bf16 v[216:219], v[40:43], v[24:27], v[216:219]
    s_mov_b32 m0, s12
    s_nop 0
    buffer_load_dwordx4 v6, s[48:51], s11 offen lds
    s_add_u32 s11, s11, 131072
    s_add_u32 s12, s12, 8192
    ds_read_b64_tr_b16 v[24:25], v8 offset:16384
    ds_read_b64_tr_b16 v[26:27], v8 offset:20480
    s_waitcnt lgkmcnt(6)
    v_mfma_f32_16x16x32_bf16 v[188:191], v[28:31], v[28:31], v[188:191]
    v_mfma_f32_16x16x32_bf16 v[220:223], v[40:43], v[28:31], v[220:223]
    buffer_load_dwordx4 v[60:63], v250, s[64:67], s22 offen offset:1024
    ds_read_b64_tr_b16 v[28:29], v9 offset:16384
    ds_read_b64_tr_b16 v[30:31], v9 offset:20480
    s_waitcnt lgkmcnt(6)
    v_mfma_f32_16x16x32_bf16 v[192:195], v[32:35], v[32:35], v[192:195]
    v_mfma_f32_16x16x32_bf16 v[224:227], v[40:43], v[32:35], v[224:227]
    s_mov_b32 m0, s12
    s_nop 0
    buffer_load_dwordx4 v6, s[48:51], s11 offen lds
    s_add_u32 s11, s11, 131072
    s_add_u32 s12, s12, 8192
    ds_read_b64_tr_b16 v[32:33], v10 offset:16384
    ds_read_b64_tr_b16 v[34:35], v10 offset:20480
    s_waitcnt lgkmcnt(6)
    v_mfma_f32_16x16x32_bf16 v[196:199], v[36:39], v[36:39], v[196:199]
    v_mfma_f32_16x16x32_bf16 v[228:231], v[40:43], v[36:39], v[228:231]
    ds_read_b64_tr_b16 v[36:37], v11 offset:16384
    ds_read_b64_tr_b16 v[38:39], v11 offset:20480
    s_waitcnt lgkmcnt(6)
    v_mfma_f32_16x16x32_bf16 v[168:171], v[24:27], v[24:27], v[168:171]
    v_mfma_f32_16x16x32_bf16 v[200:203], v[40:43], v[24:27], v[200:203]
    s_mov_b32 m0, s12
    s_nop 0
    buffer_load_dwordx4 v6, s[48:51], s11 offen lds
    s_add_u32 s11, s11, 131072
    s_add_u32 s12, s12, 8192
    ds_read_b64_tr_b16 v[24:25], v12 offset:16384
    ds_read_b64_tr_b16 v[26:27], v12 offset:20480
    s_waitcnt lgkmcnt(6)
    v_mfma_f32_16x16x32_bf16 v[172:175], v[28:31], v[28:31], v[172:175]
    v_mfma_f32_16x16x32_bf16 v[204:207], v[40:43], v[28:31], v[204:207]
    ds_read_b64_tr_b16 v[28:29], v13 offset:16384
    ds_read_b64_tr_b16 v[30:31], v13 offset:20480
    s_waitcnt lgkmcnt(6)
    v_mfma_f32_16x16x32_bf16 v[176:179], v[32:35], v[32:35], v[176:179]
    v_mfma_f32_16x16x32_bf16 v[208:211], v[40:43], v[32:35], v[208:211]
    s_mov_b32 m0, s12
    s_nop 0
    buffer_load_dwordx4 v6, s[48:51], s11 offen lds
    ds_read_b64_tr_b16 v[32:33], v14 offset:16384
    ds_read_b64_tr_b16 v[34:35], v14 offset:20480
    s_waitcnt lgkmcnt(6)
    v_mfma_f32_16x16x32_bf16 v[180:183], v[36:39], v[36:39], v[180:183]
    v_mfma_f32_16x16x32_bf16 v[212:215], v[40:43], v[36:39], v[212:215]
    buffer_load_dwordx4 v[64:67], v250, s[64:67], s22 offen offset:2048
    ds_read_b64_tr_b16 v[36:37], v15 offset:16384
    ds_read_b64_tr_b16 v[38:39], v15 offset:20480
    s_waitcnt lgkmcnt(6)
    v_mfma_f32_16x16x32_bf16 v[184:187], v[24:27], v[24:27], v[184:187]
    v_mfma_f32_16x16x32_bf16 v[216:219], v[40:43], v[24:27], v[216:219]
    ds_read_b64_tr_b16 v[24:25], v8 offset:24576
    ds_read_b64_tr_b16 v[26:27], v8 offset:28672
    s_waitcnt lgkmcnt(6)
    v_mfma_f32_16x16x32_bf16 v[188:191], v[28:31], v[28:31], v[188:191]
    v_mfma_f32_16x16x32_bf16 v[220:223], v[40:43], v[28:31], v[220:223]
    buffer_load_dwordx4 v[68:71], v250, s[64:67], s22 offen offset:3072
    s_add_u32 s22, s22, 4096
    ds_read_b64_tr_b16 v[28:29], v9 offset:24576
    ds_read_b64_tr_b16 v[30:31], v9 offset:28672
    s_waitcnt lgkmcnt(6)
    v_mfma_f32_16x16x32_bf16 v[192:195], v[32:35], v[32:35], v[192:195]
    v_mfma_f32_16x16x32_bf16 v[224:227], v[40:43], v[32:35], v[224:227]
    ds_read_b64_tr_b16 v[32:33], v10 offset:24576
    ds_read_b64_tr_b16 v[34:35], v10 offset:28672
    s_waitcnt lgkmcnt(6)
    v_mfma_f32_16x16x32_bf16 v[196:199], v[36:39], v[36:39], v[196:199]
    v_mfma_f32_16x16x32_bf16 v[228:231], v[40:43], v[36:39], v[228:231]
    ds_read_b64_tr_b16 v[36:37], v11 offset:24576
    ds_read_b64_tr_b16 v[38:39], v11 offset:28672
    s_waitcnt lgkmcnt(6)
    v_mfma_f32_16x16x32_bf16 v[168:171], v[24:27], v[24:27], v[168:171]
    v_mfma_f32_16x16x32_bf16 v[200:203], v[40:43], v[24:27], v[200:203]
    ds_read_b64_tr_b16 v[24:25], v12 offset:24576
    ds_read_b64_tr_b16 v[26:27], v12 offset:28672
    s_waitcnt lgkmcnt(6)
    v_mfma_f32_16x16x32_bf16 v[172:175], v[28:31], v[28:31], v[172:175]
    v_mfma_f32_16x16x32_bf16 v[204:207], v[40:43], v[28:31], v[204:207]
    ds_read_b64_tr_b16 v[28:29], v13 offset:24576
    ds_read_b64_tr_b16 v[30:31], v13 offset:28672
    s_waitcnt lgkmcnt(6)
    v_mfma_f32_16x16x32_bf16 v[176:179], v[32:35], v[32:35], v[176:179]
    v_mfma_f32_16x16x32_bf16 v[208:211], v[40:43], v[32:35], v[208:211]
    ds_read_b64_tr_b16 v[32:33], v14 offset:24576
    ds_read_b64_tr_b16 v[34:35], v14 offset:28672
    s_waitcnt lgkmcnt(6)
    v_mfma_f32_16x16x32_bf16 v[180:183], v[36:39], v[36:39], v[180:183]
    v_mfma_f32_16x16x32_bf16 v[212:215], v[40:43], v[36:39], v[212:215]
    buffer_load_dwordx4 v[72:75], v250, s[64:67], s22 offen offset:0
    ds_read_b64_tr_b16 v[36:37], v15 offset:24576
    ds_read_b64_tr_b16 v[38:39], v15 offset:28672
    s_waitcnt lgkmcnt(6)
    v_mfma_f32_16x16x32_bf16 v[184:187], v[24:27], v[24:27], v[184:187]
    v_mfma_f32_16x16x32_bf16 v[216:219], v[40:43], v[24:27], v[216:219]
    s_waitcnt vmcnt(3)
    s_barrier
    ds_read_b64_tr_b16 v[24:25], v8 offset:32768
    ds_read_b64_tr_b16 v[26:27], v8 offset:36864
    s_waitcnt lgkmcnt(6)
    v_mfma_f32_16x16x32_bf16 v[188:191], v[28:31], v[28:31], v[188:191]
    v_mfma_f32_16x16x32_bf16 v[220:223], v[40:43], v[28:31], v[220:223]
    buffer_load_dwordx4 v[76:79], v250, s[64:67], s22 offen offset:1024
    ds_read_b64_tr_b16 v[28:29], v9 offset:32768
    ds_read_b64_tr_b16 v[30:31], v9 offset:36864
    s_waitcnt lgkmcnt(6)
    v_mfma_f32_16x16x32_bf16 v[192:195], v[32:35], v[32:35], v[192:195]
    v_mfma_f32_16x16x32_bf16 v[224:227], v[40:43], v[32:35], v[224:227]
    ds_read_b64_tr_b16 v[32:33], v10 offset:32768
    ds_read_b64_tr_b16 v[34:35], v10 offset:36864
    s_waitcnt lgkmcnt(6)
    v_mfma_f32_16x16x32_bf16 v[196:199], v[36:39], v[36:39], v[196:199]
    v_mfma_f32_16x16x32_bf16 v[228:231], v[40:43], v[36:39], v[228:231]
    ds_read_b64_tr_b16 v[36:37], v11 offset:32768
    ds_read_b64_tr_b16 v[38:39], v11 offset:36864
    s_waitcnt lgkmcnt(6)
    v_mfma_f32_16x16x32_bf16 v[168:171], v[24:27], v[24:27], v[168:171]
    v_mfma_f32_16x16x32_bf16 v[200:203], v[40:43], v[24:27], v[200:203]
    ds_read_b64_tr_b16 v[24:25], v12 offset:32768
    ds_read_b64_tr_b16 v[26:27], v12 offset:36864
    s_waitcnt lgkmcnt(6)
    v_mfma_f32_16x16x32_bf16 v[172:175], v[28:31], v[28:31], v[172:175]
    v_mfma_f32_16x16x32_bf16 v[204:207], v[40:43], v[28:31], v[204:207]
    ds_read_b64_tr_b16 v[28:29], v13 offset:32768
    ds_read_b64_tr_b16 v[30:31], v13 offset:36864
    s_waitcnt lgkmcnt(6)
    v_mfma_f32_16x16x32_bf16 v[176:179], v[32:35], v[32:35], v[176:179]
    v_mfma_f32_16x16x32_bf16 v[208:211], v[40:43], v[32:35], v[208:211]
    ds_read_b64_tr_b16 v[32:33], v14 offset:32768
    ds_read_b64_tr_b16 v[34:35], v14 offset:36864
    s_waitcnt lgkmcnt(6)
    v_mfma_f32_16x16x32_bf16 v[180:183], v[36:39], v[36:39], v[180:183]
    v_mfma_f32_16x16x32_bf16 v[212:215], v[40:43], v[36:39], v[212:215]
    buffer_load_dwordx4 v[80:83], v250, s[64:67], s22 offen offset:2048
    ds_read_b64_tr_b16 v[36:37], v15 offset:32768
    ds_read_b64_tr_b16 v[38:39], v15 offset:36864
    s_waitcnt lgkmcnt(6)
    v_mfma_f32_16x16x32_bf16 v[184:187], v[24:27], v[24:27], v[184:187]
    v_mfma_f32_16x16x32_bf16 v[216:219], v[40:43], v[24:27], v[216:219]
    ds_read_b64_tr_b16 v[24:25], v8 offset:40960
    ds_read_b64_tr_b16 v[26:27], v8 offset:45056
    s_waitcnt lgkmcnt(6)
    v_mfma_f32_16x16x32_bf16 v[188:191], v[28:31], v[28:31], v[188:191]
    v_mfma_f32_16x16x32_bf16 v[220:223], v[40:43], v[28:31], v[220:223]
    buffer_load_dwordx4 v[84:87], v250, s[64:67], s22 offen offset:3072
    s_add_u32 s22, s22, 4096
    ds_read_b64_tr_b16 v[28:29], v9 offset:40960
    ds_read_b64_tr_b16 v[30:31], v9 offset:45056
    s_waitcnt lgkmcnt(6)
    v_mfma_f32_16x16x32_bf16 v[192:195], v[32:35], v[32:35], v[192:195]
    v_mfma_f32_16x16x32_bf16 v[224:227], v[40:43], v[32:35], v[224:227]
    ds_read_b64_tr_b16 v[32:33], v10 offset:40960
    ds_read_b64_tr_b16 v[34:35], v10 offset:45056
    s_waitcnt lgkmcnt(6)
    v_mfma_f32_16x16x32_bf16 v[196:199], v[36:39], v[36:39], v[196:199]
    v_mfma_f32_16x16x32_bf16 v[228:231], v[40:43], v[36:39], v[228:231]
    ds_read_b64_tr_b16 v[36:37], v11 offset:40960
    ds_read_b64_tr_b16 v[38:39], v11 offset:45056
    s_waitcnt lgkmcnt(6)
    v_mfma_f32_16x16x32_bf16 v[168:171], v[24:27], v[24:27], v[168:171]
    v_mfma_f32_16x16x32_bf16 v[200:203], v[40:43], v[24:27], v[200:203]
    ds_read_b64_tr_b16 v[24:25], v12 offset:40960
    ds_read_b64_tr_b16 v[26:27], v12 offset:45056
    s_waitcnt lgkmcnt(6)
    v_mfma_f32_16x16x32_bf16 v[172:175], v[28:31], v[28:31], v[172:175]
    v_mfma_f32_16x16x32_bf16 v[204:207], v[40:43], v[28:31], v[204:207]
    ds_read_b64_tr_b16 v[28:29], v13 offset:40960
    ds_read_b64_tr_b16 v[30:31], v13 offset:45056
    s_waitcnt lgkmcnt(6)
    v_mfma_f32_16x16x32_bf16 v[176:179], v[32:35], v[32:35], v[176:179]
    v_mfma_f32_16x16x32_bf16 v[208:211], v[40:43], v[32:35], v[208:211]
    ds_read_b64_tr_b16 v[32:33], v14 offset:40960
    ds_read_b64_tr_b16 v[34:35], v14 offset:45056
    s_waitcnt lgkmcnt(6)
    v_mfma_f32_16x16x32_bf16 v[180:183], v[36:39], v[36:39], v[180:183]
    v_mfma_f32_16x16x32_bf16 v[212:215], v[40:43], v[36:39], v[212:215]
    buffer_load_dwordx4 v[88:91], v250, s[64:67], s22 offen offset:0
    ds_read_b64_tr_b16 v[36:37], v15 offset:40960
    ds_read_b64_tr_b16 v[38:39], v15 offset:45056
    s_waitcnt lgkmcnt(6)
    v_mfma_f32_16x16x32_bf16 v[184:187], v[24:27], v[24:27], v[184:187]
    v_mfma_f32_16x16x32_bf16 v[216:219], v[40:43], v[24:27], v[216:219]
    ds_read_b64_tr_b16 v[24:25], v8 offset:49152
    ds_read_b64_tr_b16 v[26:27], v8 offset:53248
    s_waitcnt lgkmcnt(6)
    v_mfma_f32_16x16x32_bf16 v[188:191], v[28:31], v[28:31], v[188:191]
    v_mfma_f32_16x16x32_bf16 v[220:223], v[40:43], v[28:31], v[220:223]
    buffer_load_dwordx4 v[92:95], v250, s[64:67], s22 offen offset:1024
    ds_read_b64_tr_b16 v[28:29], v9 offset:49152
    ds_read_b64_tr_b16 v[30:31], v9 offset:53248
    s_waitcnt lgkmcnt(6)
    v_mfma_f32_16x16x32_bf16 v[192:195], v[32:35], v[32:35], v[192:195]
    v_mfma_f32_16x16x32_bf16 v[224:227], v[40:43], v[32:35], v[224:227]
    ds_read_b64_tr_b16 v[32:33], v10 offset:49152
    ds_read_b64_tr_b16 v[34:35], v10 offset:53248
    s_waitcnt lgkmcnt(6)
    v_mfma_f32_16x16x32_bf16 v[196:199], v[36:39], v[36:39], v[196:199]
    v_mfma_f32_16x16x32_bf16 v[228:231], v[40:43], v[36:39], v[228:231]
    ds_read_b64_tr_b16 v[36:37], v11 offset:49152
    ds_read_b64_tr_b16 v[38:39], v11 offset:53248
    s_waitcnt lgkmcnt(6)
    v_mfma_f32_16x16x32_bf16 v[168:171], v[24:27], v[24:27], v[168:171]
    v_mfma_f32_16x16x32_bf16 v[200:203], v[40:43], v[24:27], v[200:203]
    ds_read_b64_tr_b16 v[24:25], v12 offset:49152
    ds_read_b64_tr_b16 v[26:27], v12 offset:53248
    s_waitcnt lgkmcnt(6)
    v_mfma_f32_16x16x32_bf16 v[172:175], v[28:31], v[28:31], v[172:175]
    v_mfma_f32_16x16x32_bf16 v[204:207], v[40:43], v[28:31], v[204:207]
    ds_read_b64_tr_b16 v[28:29], v13 offset:49152
    ds_read_b64_tr_b16 v[30:31], v13 offset:53248
    s_waitcnt lgkmcnt(6)
    v_mfma_f32_16x16x32_bf16 v[176:179], v[32:35], v[32:35], v[176:179]
    v_mfma_f32_16x16x32_bf16 v[208:211], v[40:43], v[32:35], v[208:211]
    ds_read_b64_tr_b16 v[32:33], v14 offset:49152
    ds_read_b64_tr_b16 v[34:35], v14 offset:53248
    s_waitcnt lgkmcnt(6)
    v_mfma_f32_16x16x32_bf16 v[180:183], v[36:39], v[36:39], v[180:183]
    v_mfma_f32_16x16x32_bf16 v[212:215], v[40:43], v[36:39], v[212:215]
    buffer_load_dwordx4 v[96:99], v250, s[64:67], s22 offen offset:2048
    ds_read_b64_tr_b16 v[36:37], v15 offset:49152
    ds_read_b64_tr_b16 v[38:39], v15 offset:53248
    s_waitcnt lgkmcnt(6)
    v_mfma_f32_16x16x32_bf16 v[184:187], v[24:27], v[24:27], v[184:187]
    v_mfma_f32_16x16x32_bf16 v[216:219], v[40:43], v[24:27], v[216:219]
    ds_read_b64_tr_b16 v[24:25], v8 offset:57344
    ds_read_b64_tr_b16 v[26:27], v8 offset:61440
    s_waitcnt lgkmcnt(6)
    v_mfma_f32_16x16x32_bf16 v[188:191], v[28:31], v[28:31], v[188:191]
    v_mfma_f32_16x16x32_bf16 v[220:223], v[40:43], v[28:31], v[220:223]
    buffer_load_dwordx4 v[100:103], v250, s[64:67], s22 offen offset:3072
    s_add_u32 s22, s22, 4096
    ds_read_b64_tr_b16 v[28:29], v9 offset:57344
    ds_read_b64_tr_b16 v[30:31], v9 offset:61440
    s_waitcnt lgkmcnt(6)
    v_mfma_f32_16x16x32_bf16 v[192:195], v[32:35], v[32:35], v[192:195]
    v_mfma_f32_16x16x32_bf16 v[224:227], v[40:43], v[32:35], v[224:227]
    ds_read_b64_tr_b16 v[32:33], v10 offset:57344
    ds_read_b64_tr_b16 v[34:35], v10 offset:61440
    s_waitcnt lgkmcnt(6)
    v_mfma_f32_16x16x32_bf16 v[196:199], v[36:39], v[36:39], v[196:199]
    v_mfma_f32_16x16x32_bf16 v[228:231], v[40:43], v[36:39], v[228:231]
    ds_read_b64_tr_b16 v[36:37], v11 offset:57344
    ds_read_b64_tr_b16 v[38:39], v11 offset:61440
    s_waitcnt lgkmcnt(6)
    v_mfma_f32_16x16x32_bf16 v[168:171], v[24:27], v[24:27], v[168:171]
    v_mfma_f32_16x16x32_bf16 v[200:203], v[40:43], v[24:27], v[200:203]
    ds_read_b64_tr_b16 v[24:25], v12 offset:57344
    ds_read_b64_tr_b16 v[26:27], v12 offset:61440
    s_waitcnt lgkmcnt(6)
    v_mfma_f32_16x16x32_bf16 v[172:175], v[28:31], v[28:31], v[172:175]
    v_mfma_f32_16x16x32_bf16 v[204:207], v[40:43], v[28:31], v[204:207]
    ds_read_b64_tr_b16 v[28:29], v13 offset:57344
    ds_read_b64_tr_b16 v[30:31], v13 offset:61440
    s_waitcnt lgkmcnt(6)
    v_mfma_f32_16x16x32_bf16 v[176:179], v[32:35], v[32:35], v[176:179]
    v_mfma_f32_16x16x32_bf16 v[208:211], v[40:43], v[32:35], v[208:211]
    ds_read_b64_tr_b16 v[32:33], v14 offset:57344
    ds_read_b64_tr_b16 v[34:35], v14 offset:61440
    s_waitcnt lgkmcnt(6)
    v_mfma_f32_16x16x32_bf16 v[180:183], v[36:39], v[36:39], v[180:183]
    v_mfma_f32_16x16x32_bf16 v[212:215], v[40:43], v[36:39], v[212:215]
    buffer_load_dwordx4 v[104:107], v250, s[64:67], s22 offen offset:0
    ds_read_b64_tr_b16 v[36:37], v15 offset:57344
    ds_read_b64_tr_b16 v[38:39], v15 offset:61440
    s_waitcnt lgkmcnt(6)
    v_mfma_f32_16x16x32_bf16 v[184:187], v[24:27], v[24:27], v[184:187]
    v_mfma_f32_16x16x32_bf16 v[216:219], v[40:43], v[24:27], v[216:219]
    ds_read_b64_tr_b16 v[24:25], v16 offset:0
    ds_read_b64_tr_b16 v[26:27], v16 offset:4096
    s_waitcnt lgkmcnt(6)
    v_mfma_f32_16x16x32_bf16 v[188:191], v[28:31], v[28:31], v[188:191]
    v_mfma_f32_16x16x32_bf16 v[220:223], v[40:43], v[28:31], v[220:223]
    buffer_load_dwordx4 v[108:111], v250, s[64:67], s22 offen offset:1024
    ds_read_b64_tr_b16 v[28:29], v17 offset:0
    ds_read_b64_tr_b16 v[30:31], v17 offset:4096
    s_waitcnt lgkmcnt(6)
    v_mfma_f32_16x16x32_bf16 v[192:195], v[32:35], v[32:35], v[192:195]
    v_mfma_f32_16x16x32_bf16 v[224:227], v[40:43], v[32:35], v[224:227]
    ds_read_b64_tr_b16 v[32:33], v18 offset:0
    ds_read_b64_tr_b16 v[34:35], v18 offset:4096
    s_waitcnt lgkmcnt(6)
    v_mfma_f32_16x16x32_bf16 v[196:199], v[36:39], v[36:39], v[196:199]
    v_mfma_f32_16x16x32_bf16 v[228:231], v[40:43], v[36:39], v[228:231]
    ds_read_b64_tr_b16 v[36:37], v19 offset:0
    ds_read_b64_tr_b16 v[38:39], v19 offset:4096
    s_waitcnt lgkmcnt(6)
    v_mfma_f32_16x16x32_bf16 v[168:171], v[24:27], v[24:27], v[168:171]
    v_mfma_f32_16x16x32_bf16 v[200:203], v[40:43], v[24:27], v[200:203]
    ds_read_b64_tr_b16 v[24:25], v20 offset:0
    ds_read_b64_tr_b16 v[26:27], v20 offset:4096
    s_waitcnt lgkmcnt(6)
    v_mfma_f32_16x16x32_bf16 v[172:175], v[28:31], v[28:31], v[172:175]
    v_mfma_f32_16x16x32_bf16 v[204:207], v[40:43], v[28:31], v[204:207]
    ds_read_b64_tr_b16 v[28:29], v21 offset:0
    ds_read_b64_tr_b16 v[30:31], v21 offset:4096
    s_waitcnt lgkmcnt(6)
    v_mfma_f32_16x16x32_bf16 v[176:179], v[32:35], v[32:35], v[176:179]
    v_mfma_f32_16x16x32_bf16 v[208:211], v[40:43], v[32:35], v[208:211]
    ds_read_b64_tr_b16 v[32:33], v22 offset:0
    ds_read_b64_tr_b16 v[34:35], v22 offset:4096
    s_waitcnt lgkmcnt(6)
    v_mfma_f32_16x16x32_bf16 v[180:183], v[36:39], v[36:39], v[180:183]
    v_mfma_f32_16x16x32_bf16 v[212:215], v[40:43], v[36:39], v[212:215]
    buffer_load_dwordx4 v[112:115], v250, s[64:67], s22 offen offset:2048
    ds_read_b64_tr_b16 v[36:37], v23 offset:0
    ds_read_b64_tr_b16 v[38:39], v23 offset:4096
    s_waitcnt lgkmcnt(6)
    v_mfma_f32_16x16x32_bf16 v[184:187], v[24:27], v[24:27], v[184:187]
    v_mfma_f32_16x16x32_bf16 v[216:219], v[40:43], v[24:27], v[216:219]
    ds_read_b64_tr_b16 v[24:25], v16 offset:8192
    ds_read_b64_tr_b16 v[26:27], v16 offset:12288
    s_waitcnt lgkmcnt(6)
    v_mfma_f32_16x16x32_bf16 v[188:191], v[28:31], v[28:31], v[188:191]
    v_mfma_f32_16x16x32_bf16 v[220:223], v[40:43], v[28:31], v[220:223]
    buffer_load_dwordx4 v[116:119], v250, s[64:67], s22 offen offset:3072
    s_add_u32 s22, s22, 4096
    ds_read_b64_tr_b16 v[28:29], v17 offset:8192
    ds_read_b64_tr_b16 v[30:31], v17 offset:12288
    s_waitcnt lgkmcnt(6)
    v_mfma_f32_16x16x32_bf16 v[192:195], v[32:35], v[32:35], v[192:195]
    v_mfma_f32_16x16x32_bf16 v[224:227], v[40:43], v[32:35], v[224:227]
    ds_read_b64_tr_b16 v[32:33], v18 offset:8192
    ds_read_b64_tr_b16 v[34:35], v18 offset:12288
    s_waitcnt lgkmcnt(6)
    v_mfma_f32_16x16x32_bf16 v[196:199], v[36:39], v[36:39], v[196:199]
    v_mfma_f32_16x16x32_bf16 v[228:231], v[40:43], v[36:39], v[228:231]
    ds_read_b64_tr_b16 v[36:37], v19 offset:8192
    ds_read_b64_tr_b16 v[38:39], v19 offset:12288
    s_waitcnt lgkmcnt(6)
    v_mfma_f32_16x16x32_bf16 v[168:171], v[24:27], v[24:27], v[168:171]
    v_mfma_f32_16x16x32_bf16 v[200:203], v[40:43], v[24:27], v[200:203]
    ds_read_b64_tr_b16 v[24:25], v20 offset:8192
    ds_read_b64_tr_b16 v[26:27], v20 offset:12288
    s_waitcnt lgkmcnt(6)
    v_mfma_f32_16x16x32_bf16 v[172:175], v[28:31], v[28:31], v[172:175]
    v_mfma_f32_16x16x32_bf16 v[204:207], v[40:43], v[28:31], v[204:207]
    ds_read_b64_tr_b16 v[28:29], v21 offset:8192
    ds_read_b64_tr_b16 v[30:31], v21 offset:12288
    s_waitcnt lgkmcnt(6)
    v_mfma_f32_16x16x32_bf16 v[176:179], v[32:35], v[32:35], v[176:179]
    v_mfma_f32_16x16x32_bf16 v[208:211], v[40:43], v[32:35], v[208:211]
    ds_read_b64_tr_b16 v[32:33], v22 offset:8192
    ds_read_b64_tr_b16 v[34:35], v22 offset:12288
    s_waitcnt lgkmcnt(6)
    v_mfma_f32_16x16x32_bf16 v[180:183], v[36:39], v[36:39], v[180:183]
    v_mfma_f32_16x16x32_bf16 v[212:215], v[40:43], v[36:39], v[212:215]
    buffer_load_dwordx4 v[120:123], v250, s[64:67], s22 offen offset:0
    ds_read_b64_tr_b16 v[36:37], v23 offset:8192
    ds_read_b64_tr_b16 v[38:39], v23 offset:12288
    s_waitcnt lgkmcnt(6)
    v_mfma_f32_16x16x32_bf16 v[184:187], v[24:27], v[24:27], v[184:187]
    v_mfma_f32_16x16x32_bf16 v[216:219], v[40:43], v[24:27], v[216:219]
    ds_read_b64_tr_b16 v[24:25], v16 offset:16384
    ds_read_b64_tr_b16 v[26:27], v16 offset:20480
    s_waitcnt lgkmcnt(6)
    v_mfma_f32_16x16x32_bf16 v[188:191], v[28:31], v[28:31], v[188:191]
    v_mfma_f32_16x16x32_bf16 v[220:223], v[40:43], v[28:31], v[220:223]
    buffer_load_dwordx4 v[124:127], v250, s[64:67], s22 offen offset:1024
    ds_read_b64_tr_b16 v[28:29], v17 offset:16384
    ds_read_b64_tr_b16 v[30:31], v17 offset:20480
    s_waitcnt lgkmcnt(6)
    v_mfma_f32_16x16x32_bf16 v[192:195], v[32:35], v[32:35], v[192:195]
    v_mfma_f32_16x16x32_bf16 v[224:227], v[40:43], v[32:35], v[224:227]
    ds_read_b64_tr_b16 v[32:33], v18 offset:16384
    ds_read_b64_tr_b16 v[34:35], v18 offset:20480
    s_waitcnt lgkmcnt(6)
    v_mfma_f32_16x16x32_bf16 v[196:199], v[36:39], v[36:39], v[196:199]
    v_mfma_f32_16x16x32_bf16 v[228:231], v[40:43], v[36:39], v[228:231]
    ds_read_b64_tr_b16 v[36:37], v19 offset:16384
    ds_read_b64_tr_b16 v[38:39], v19 offset:20480
    s_waitcnt lgkmcnt(6)
    v_mfma_f32_16x16x32_bf16 v[168:171], v[24:27], v[24:27], v[168:171]
    v_mfma_f32_16x16x32_bf16 v[200:203], v[40:43], v[24:27], v[200:203]
    ds_read_b64_tr_b16 v[24:25], v20 offset:16384
    ds_read_b64_tr_b16 v[26:27], v20 offset:20480
    s_waitcnt lgkmcnt(6)
    v_mfma_f32_16x16x32_bf16 v[172:175], v[28:31], v[28:31], v[172:175]
    v_mfma_f32_16x16x32_bf16 v[204:207], v[40:43], v[28:31], v[204:207]
    ds_read_b64_tr_b16 v[28:29], v21 offset:16384
    ds_read_b64_tr_b16 v[30:31], v21 offset:20480
    s_waitcnt lgkmcnt(6)
    v_mfma_f32_16x16x32_bf16 v[176:179], v[32:35], v[32:35], v[176:179]
    v_mfma_f32_16x16x32_bf16 v[208:211], v[40:43], v[32:35], v[208:211]
    ds_read_b64_tr_b16 v[32:33], v22 offset:16384
    ds_read_b64_tr_b16 v[34:35], v22 offset:20480
    s_waitcnt lgkmcnt(6)
    v_mfma_f32_16x16x32_bf16 v[180:183], v[36:39], v[36:39], v[180:183]
    v_mfma_f32_16x16x32_bf16 v[212:215], v[40:43], v[36:39], v[212:215]
    buffer_load_dwordx4 v[128:131], v250, s[64:67], s22 offen offset:2048
    ds_read_b64_tr_b16 v[36:37], v23 offset:16384
    ds_read_b64_tr_b16 v[38:39], v23 offset:20480
    s_waitcnt lgkmcnt(6)
    v_mfma_f32_16x16x32_bf16 v[184:187], v[24:27], v[24:27], v[184:187]
    v_mfma_f32_16x16x32_bf16 v[216:219], v[40:43], v[24:27], v[216:219]
    ds_read_b64_tr_b16 v[24:25], v16 offset:24576
    ds_read_b64_tr_b16 v[26:27], v16 offset:28672
    s_waitcnt lgkmcnt(6)
    v_mfma_f32_16x16x32_bf16 v[188:191], v[28:31], v[28:31], v[188:191]
    v_mfma_f32_16x16x32_bf16 v[220:223], v[40:43], v[28:31], v[220:223]
    buffer_load_dwordx4 v[132:135], v250, s[64:67], s22 offen offset:3072
    s_add_u32 s22, s22, 4096
    ds_read_b64_tr_b16 v[28:29], v17 offset:24576
    ds_read_b64_tr_b16 v[30:31], v17 offset:28672
    s_waitcnt lgkmcnt(6)
    v_mfma_f32_16x16x32_bf16 v[192:195], v[32:35], v[32:35], v[192:195]
    v_mfma_f32_16x16x32_bf16 v[224:227], v[40:43], v[32:35], v[224:227]
    ds_read_b64_tr_b16 v[32:33], v18 offset:24576
    ds_read_b64_tr_b16 v[34:35], v18 offset:28672
    s_waitcnt lgkmcnt(6)
    v_mfma_f32_16x16x32_bf16 v[196:199], v[36:39], v[36:39], v[196:199]
    v_mfma_f32_16x16x32_bf16 v[228:231], v[40:43], v[36:39], v[228:231]
    ds_read_b64_tr_b16 v[36:37], v19 offset:24576
    ds_read_b64_tr_b16 v[38:39], v19 offset:28672
    s_waitcnt lgkmcnt(6)
    v_mfma_f32_16x16x32_bf16 v[168:171], v[24:27], v[24:27], v[168:171]
    v_mfma_f32_16x16x32_bf16 v[200:203], v[40:43], v[24:27], v[200:203]
    ds_read_b64_tr_b16 v[24:25], v20 offset:24576
    ds_read_b64_tr_b16 v[26:27], v20 offset:28672
    s_waitcnt lgkmcnt(6)
    v_mfma_f32_16x16x32_bf16 v[172:175], v[28:31], v[28:31], v[172:175]
    v_mfma_f32_16x16x32_bf16 v[204:207], v[40:43], v[28:31], v[204:207]
    ds_read_b64_tr_b16 v[28:29], v21 offset:24576
    ds_read_b64_tr_b16 v[30:31], v21 offset:28672
    s_waitcnt lgkmcnt(6)
    v_mfma_f32_16x16x32_bf16 v[176:179], v[32:35], v[32:35], v[176:179]
    v_mfma_f32_16x16x32_bf16 v[208:211], v[40:43], v[32:35], v[208:211]
    ds_read_b64_tr_b16 v[32:33], v22 offset:24576
    ds_read_b64_tr_b16 v[34:35], v22 offset:28672
    s_waitcnt lgkmcnt(6)
    v_mfma_f32_16x16x32_bf16 v[180:183], v[36:39], v[36:39], v[180:183]
    v_mfma_f32_16x16x32_bf16 v[212:215], v[40:43], v[36:39], v[212:215]
    buffer_load_dwordx4 v[136:139], v250, s[64:67], s22 offen offset:0
    ds_read_b64_tr_b16 v[36:37], v23 offset:24576
    ds_read_b64_tr_b16 v[38:39], v23 offset:28672
    s_waitcnt lgkmcnt(6)
    v_mfma_f32_16x16x32_bf16 v[184:187], v[24:27], v[24:27], v[184:187]
    v_mfma_f32_16x16x32_bf16 v[216:219], v[40:43], v[24:27], v[216:219]
    ds_read_b64_tr_b16 v[24:25], v16 offset:32768
    ds_read_b64_tr_b16 v[26:27], v16 offset:36864
    s_waitcnt lgkmcnt(6)
    v_mfma_f32_16x16x32_bf16 v[188:191], v[28:31], v[28:31], v[188:191]
    v_mfma_f32_16x16x32_bf16 v[220:223], v[40:43], v[28:31], v[220:223]
    buffer_load_dwordx4 v[140:143], v250, s[64:67], s22 offen offset:1024
    ds_read_b64_tr_b16 v[28:29], v17 offset:32768
    ds_read_b64_tr_b16 v[30:31], v17 offset:36864
    s_waitcnt lgkmcnt(6)
    v_mfma_f32_16x16x32_bf16 v[192:195], v[32:35], v[32:35], v[192:195]
    v_mfma_f32_16x16x32_bf16 v[224:227], v[40:43], v[32:35], v[224:227]
    ds_read_b64_tr_b16 v[32:33], v18 offset:32768
    ds_read_b64_tr_b16 v[34:35], v18 offset:36864
    s_waitcnt lgkmcnt(6)
    v_mfma_f32_16x16x32_bf16 v[196:199], v[36:39], v[36:39], v[196:199]
    v_mfma_f32_16x16x32_bf16 v[228:231], v[40:43], v[36:39], v[228:231]
    ds_read_b64_tr_b16 v[36:37], v19 offset:32768
    ds_read_b64_tr_b16 v[38:39], v19 offset:36864
    s_waitcnt lgkmcnt(6)
    v_mfma_f32_16x16x32_bf16 v[168:171], v[24:27], v[24:27], v[168:171]
    v_mfma_f32_16x16x32_bf16 v[200:203], v[40:43], v[24:27], v[200:203]
    ds_read_b64_tr_b16 v[24:25], v20 offset:32768
    ds_read_b64_tr_b16 v[26:27], v20 offset:36864
    s_waitcnt lgkmcnt(6)
    v_mfma_f32_16x16x32_bf16 v[172:175], v[28:31], v[28:31], v[172:175]
    v_mfma_f32_16x16x32_bf16 v[204:207], v[40:43], v[28:31], v[204:207]
    ds_read_b64_tr_b16 v[28:29], v21 offset:32768
    ds_read_b64_tr_b16 v[30:31], v21 offset:36864
    s_waitcnt lgkmcnt(6)
    v_mfma_f32_16x16x32_bf16 v[176:179], v[32:35], v[32:35], v[176:179]
    v_mfma_f32_16x16x32_bf16 v[208:211], v[40:43], v[32:35], v[208:211]
    ds_read_b64_tr_b16 v[32:33], v22 offset:32768
    ds_read_b64_tr_b16 v[34:35], v22 offset:36864
    s_waitcnt lgkmcnt(6)
    v_mfma_f32_16x16x32_bf16 v[180:183], v[36:39], v[36:39], v[180:183]
    v_mfma_f32_16x16x32_bf16 v[212:215], v[40:43], v[36:39], v[212:215]
    buffer_load_dwordx4 v[144:147], v250, s[64:67], s22 offen offset:2048
    ds_read_b64_tr_b16 v[36:37], v23 offset:32768
    ds_read_b64_tr_b16 v[38:39], v23 offset:36864
    s_waitcnt lgkmcnt(6)
    v_mfma_f32_16x16x32_bf16 v[184:187], v[24:27], v[24:27], v[184:187]
    v_mfma_f32_16x16x32_bf16 v[216:219], v[40:43], v[24:27], v[216:219]
    ds_read_b64_tr_b16 v[24:25], v16 offset:40960
    ds_read_b64_tr_b16 v[26:27], v16 offset:45056
    s_waitcnt lgkmcnt(6)
    v_mfma_f32_16x16x32_bf16 v[188:191], v[28:31], v[28:31], v[188:191]
    v_mfma_f32_16x16x32_bf16 v[220:223], v[40:43], v[28:31], v[220:223]
    buffer_load_dwordx4 v[148:151], v250, s[64:67], s22 offen offset:3072
    s_add_u32 s22, s22, 4096
    ds_read_b64_tr_b16 v[28:29], v17 offset:40960
    ds_read_b64_tr_b16 v[30:31], v17 offset:45056
    s_waitcnt lgkmcnt(6)
    v_mfma_f32_16x16x32_bf16 v[192:195], v[32:35], v[32:35], v[192:195]
    v_mfma_f32_16x16x32_bf16 v[224:227], v[40:43], v[32:35], v[224:227]
    ds_read_b64_tr_b16 v[32:33], v18 offset:40960
    ds_read_b64_tr_b16 v[34:35], v18 offset:45056
    s_waitcnt lgkmcnt(6)
    v_mfma_f32_16x16x32_bf16 v[196:199], v[36:39], v[36:39], v[196:199]
    v_mfma_f32_16x16x32_bf16 v[228:231], v[40:43], v[36:39], v[228:231]
    ds_read_b64_tr_b16 v[36:37], v19 offset:40960
    ds_read_b64_tr_b16 v[38:39], v19 offset:45056
    s_waitcnt lgkmcnt(6)
    v_mfma_f32_16x16x32_bf16 v[168:171], v[24:27], v[24:27], v[168:171]
    v_mfma_f32_16x16x32_bf16 v[200:203], v[40:43], v[24:27], v[200:203]
    ds_read_b64_tr_b16 v[24:25], v20 offset:40960
    ds_read_b64_tr_b16 v[26:27], v20 offset:45056
    s_waitcnt lgkmcnt(6)
    v_mfma_f32_16x16x32_bf16 v[172:175], v[28:31], v[28:31], v[172:175]
    v_mfma_f32_16x16x32_bf16 v[204:207], v[40:43], v[28:31], v[204:207]
    ds_read_b64_tr_b16 v[28:29], v21 offset:40960
    ds_read_b64_tr_b16 v[30:31], v21 offset:45056
    s_waitcnt lgkmcnt(6)
    v_mfma_f32_16x16x32_bf16 v[176:179], v[32:35], v[32:35], v[176:179]
    v_mfma_f32_16x16x32_bf16 v[208:211], v[40:43], v[32:35], v[208:211]
    ds_read_b64_tr_b16 v[32:33], v22 offset:40960
    ds_read_b64_tr_b16 v[34:35], v22 offset:45056
    s_waitcnt lgkmcnt(6)
    v_mfma_f32_16x16x32_bf16 v[180:183], v[36:39], v[36:39], v[180:183]
    v_mfma_f32_16x16x32_bf16 v[212:215], v[40:43], v[36:39], v[212:215]
    buffer_load_dwordx4 v[152:155], v250, s[64:67], s22 offen offset:0
    ds_read_b64_tr_b16 v[36:37], v23 offset:40960
    ds_read_b64_tr_b16 v[38:39], v23 offset:45056
    s_waitcnt lgkmcnt(6)
    v_mfma_f32_16x16x32_bf16 v[184:187], v[24:27], v[24:27], v[184:187]
    v_mfma_f32_16x16x32_bf16 v[216:219], v[40:43], v[24:27], v[216:219]
    s_waitcnt lgkmcnt(4)
    v_mfma_f32_16x16x32_bf16 v[188:191], v[28:31], v[28:31], v[188:191]
    v_mfma_f32_16x16x32_bf16 v[220:223], v[40:43], v[28:31], v[220:223]
    buffer_load_dwordx4 v[156:159], v250, s[64:67], s22 offen offset:1024
    s_waitcnt lgkmcnt(2)
    v_mfma_f32_16x16x32_bf16 v[192:195], v[32:35], v[32:35], v[192:195]
    v_mfma_f32_16x16x32_bf16 v[224:227], v[40:43], v[32:35], v[224:227]
    s_waitcnt lgkmcnt(0)
    v_mfma_f32_16x16x32_bf16 v[196:199], v[36:39], v[36:39], v[196:199]
    v_mfma_f32_16x16x32_bf16 v[228:231], v[40:43], v[36:39], v[228:231]
    v_and_b32 v5, 3, v4
    v_cmp_eq_u32 s[24:25], 1, v5
    v_cmp_eq_u32 s[26:27], 2, v5
    v_cmp_eq_u32 s[28:29], 3, v5
    v_lshrrev_b32 v5, 2, v4
    v_cmp_eq_u32 s[30:31], v5, v3
    v_mov_b32 v44, 0x3b124925
    v_cndmask_b32 v8, v168, v169, s[24:25]
    v_cndmask_b32 v8, v8, v170, s[26:27]
    v_cndmask_b32 v8, v8, v171, s[28:29]
    v_mul_f32 v16, v200, v44
    v_cndmask_b32 v9, v172, v173, s[24:25]
    v_cndmask_b32 v9, v9, v174, s[26:27]
    v_cndmask_b32 v9, v9, v175, s[28:29]
    v_mul_f32 v17, v204, v44
    v_cndmask_b32 v10, v176, v177, s[24:25]
    v_cndmask_b32 v10, v10, v178, s[26:27]
    v_cndmask_b32 v10, v10, v179, s[28:29]
    v_mul_f32 v18, v208, v44
    v_cndmask_b32 v11, v180, v181, s[24:25]
    v_cndmask_b32 v11, v11, v182, s[26:27]
    v_cndmask_b32 v11, v11, v183, s[28:29]
    v_mul_f32 v19, v212, v44
    v_cndmask_b32 v12, v184, v185, s[24:25]
    v_cndmask_b32 v12, v12, v186, s[26:27]
    v_cndmask_b32 v12, v12, v187, s[28:29]
    v_mul_f32 v20, v216, v44
    v_cndmask_b32 v13, v188, v189, s[24:25]
    v_cndmask_b32 v13, v13, v190, s[26:27]
    v_cndmask_b32 v13, v13, v191, s[28:29]
    v_mul_f32 v21, v220, v44
    v_cndmask_b32 v14, v192, v193, s[24:25]
    v_cndmask_b32 v14, v14, v194, s[26:27]
    v_cndmask_b32 v14, v14, v195, s[28:29]
    v_mul_f32 v22, v224, v44
    v_cndmask_b32 v15, v196, v197, s[24:25]
    v_cndmask_b32 v15, v15, v198, s[26:27]
    v_cndmask_b32 v15, v15, v199, s[28:29]
    v_mul_f32 v23, v228, v44
    v_mul_f32 v8, v8, v44
    v_mul_f32 v9, v9, v44
    v_mul_f32 v10, v10, v44
    v_mul_f32 v11, v11, v44
    v_mul_f32 v12, v12, v44
    v_mul_f32 v13, v13, v44
    v_mul_f32 v14, v14, v44
    v_mul_f32 v15, v15, v44
    v_fma_f32 v8, -v16, v16, v8
    v_fma_f32 v9, -v17, v17, v9
    v_fma_f32 v10, -v18, v18, v10
    v_fma_f32 v11, -v19, v19, v11
    v_fma_f32 v12, -v20, v20, v12
    v_fma_f32 v13, -v21, v21, v13
    v_fma_f32 v14, -v22, v22, v14
    v_fma_f32 v15, -v23, v23, v15
    v_max_f32 v8, 0, v8
    v_max_f32 v9, 0, v9
    v_max_f32 v10, 0, v10
    v_max_f32 v11, 0, v11
    v_max_f32 v12, 0, v12
    v_max_f32 v13, 0, v13
    v_max_f32 v14, 0, v14
    v_max_f32 v15, 0, v15
    v_cvt_pk_bf16_f32 v8, v8, v8
    v_lshlrev_b32 v8, 16, v8
    v_cvt_pk_bf16_f32 v16, v16, v16
    v_lshlrev_b32 v16, 16, v16
    v_cvt_pk_bf16_f32 v9, v9, v9
    v_lshlrev_b32 v9, 16, v9
    v_cvt_pk_bf16_f32 v17, v17, v17
    v_lshlrev_b32 v17, 16, v17
    v_cvt_pk_bf16_f32 v10, v10, v10
    v_lshlrev_b32 v10, 16, v10
    v_cvt_pk_bf16_f32 v18, v18, v18
    v_lshlrev_b32 v18, 16, v18
    v_cvt_pk_bf16_f32 v11, v11, v11
    v_lshlrev_b32 v11, 16, v11
    v_cvt_pk_bf16_f32 v19, v19, v19
    v_lshlrev_b32 v19, 16, v19
    v_cvt_pk_bf16_f32 v12, v12, v12
    v_lshlrev_b32 v12, 16, v12
    v_cvt_pk_bf16_f32 v20, v20, v20
    v_lshlrev_b32 v20, 16, v20
    v_cvt_pk_bf16_f32 v13, v13, v13
    v_lshlrev_b32 v13, 16, v13
    v_cvt_pk_bf16_f32 v21, v21, v21
    v_lshlrev_b32 v21, 16, v21
    v_cvt_pk_bf16_f32 v14, v14, v14
    v_lshlrev_b32 v14, 16, v14
    v_cvt_pk_bf16_f32 v22, v22, v22
    v_lshlrev_b32 v22, 16, v22
    v_cvt_pk_bf16_f32 v15, v15, v15
    v_lshlrev_b32 v15, 16, v15
    v_cvt_pk_bf16_f32 v23, v23, v23
    v_lshlrev_b32 v23, 16, v23
    v_add_f32 v8, 0x3727c5ac, v8
    v_add_f32 v9, 0x3727c5ac, v9
    v_add_f32 v10, 0x3727c5ac, v10
    v_add_f32 v11, 0x3727c5ac, v11
    v_add_f32 v12, 0x3727c5ac, v12
    v_add_f32 v13, 0x3727c5ac, v13
    v_add_f32 v14, 0x3727c5ac, v14
    v_add_f32 v15, 0x3727c5ac, v15
    v_cvt_pk_bf16_f32 v8, v8, v8
    v_lshlrev_b32 v8, 16, v8
    v_cvt_pk_bf16_f32 v9, v9, v9
    v_lshlrev_b32 v9, 16, v9
    v_cvt_pk_bf16_f32 v10, v10, v10
    v_lshlrev_b32 v10, 16, v10
    v_cvt_pk_bf16_f32 v11, v11, v11
    v_lshlrev_b32 v11, 16, v11
    v_cvt_pk_bf16_f32 v12, v12, v12
    v_lshlrev_b32 v12, 16, v12
    v_cvt_pk_bf16_f32 v13, v13, v13
    v_lshlrev_b32 v13, 16, v13
    v_cvt_pk_bf16_f32 v14, v14, v14
    v_lshlrev_b32 v14, 16, v14
    v_cvt_pk_bf16_f32 v15, v15, v15
    v_lshlrev_b32 v15, 16, v15
    v_sqrt_f32 v8, v8
    v_sqrt_f32 v9, v9
    v_sqrt_f32 v10, v10
    v_sqrt_f32 v11, v11
    v_sqrt_f32 v12, v12
    v_sqrt_f32 v13, v13
    v_sqrt_f32 v14, v14
    v_sqrt_f32 v15, v15
    v_cvt_pk_bf16_f32 v8, v8, v8
    v_lshlrev_b32 v8, 16, v8
    v_cvt_pk_bf16_f32 v9, v9, v9
    v_lshlrev_b32 v9, 16, v9
    v_cvt_pk_bf16_f32 v10, v10, v10
    v_lshlrev_b32 v10, 16, v10
    v_cvt_pk_bf16_f32 v11, v11, v11
    v_lshlrev_b32 v11, 16, v11
    v_cvt_pk_bf16_f32 v12, v12, v12
    v_lshlrev_b32 v12, 16, v12
    v_cvt_pk_bf16_f32 v13, v13, v13
    v_lshlrev_b32 v13, 16, v13
    v_cvt_pk_bf16_f32 v14, v14, v14
    v_lshlrev_b32 v14, 16, v14
    v_cvt_pk_bf16_f32 v15, v15, v15
    v_lshlrev_b32 v15, 16, v15
    v_rcp_f32 v24, v8
    v_rcp_f32 v26, v9
    v_rcp_f32 v28, v10
    v_rcp_f32 v30, v11
    v_rcp_f32 v32, v12
    v_rcp_f32 v34, v13
    v_rcp_f32 v36, v14
    v_rcp_f32 v38, v15
    v_mul_f32 v25, v24, v16
    v_mul_f32 v27, v26, v17
    v_mul_f32 v29, v28, v18
    v_mul_f32 v31, v30, v19
    v_mul_f32 v33, v32, v20
    v_mul_f32 v35, v34, v21
    v_mul_f32 v37, v36, v22
    v_mul_f32 v39, v38, v23
    v_lshlrev_b32 v5, 3, v4
    v_add_u32 v5, 131072, v5
    s_mov_b64 exec, s[30:31]
    ds_write_b64 v5, v[24:25] offset:0
    ds_write_b64 v5, v[26:27] offset:128
    ds_write_b64 v5, v[28:29] offset:256
    ds_write_b64 v5, v[30:31] offset:384
    ds_write_b64 v5, v[32:33] offset:512
    ds_write_b64 v5, v[34:35] offset:640
    ds_write_b64 v5, v[36:37] offset:768
    ds_write_b64 v5, v[38:39] offset:896
    s_mov_b64 exec, -1
    s_waitcnt lgkmcnt(0)
    v_mov_b32 v2, 1
    v_mov_b32 v5, 132096
    ds_write_b32 v5, v2
    buffer_load_dwordx4 v[160:163], v250, s[64:67], s22 offen offset:2048
    buffer_load_dwordx4 v[164:167], v250, s[64:67], s22 offen offset:3072
    s_add_u32 s22, s22, 4096
    v_bfe_u32 v244, v1, 2, 2
    v_lshl_add_u32 v244, v3, 4, v244
    s_min_u32 s18, s17, 6
    s_lshl_b32 s18, s18, 6
    s_and_b32 s19, s4, 1
    s_lshl_b32 s20, s19, 3
    s_add_u32 s18, s18, s20
    v_add_u32 v244, s18, v244
    s_lshr_b32 s20, s4, 1
    s_lshl_b32 s21, s16, 2
    s_add_u32 s21, s21, s20
    v_bfe_u32 v245, v1, 2, 2
    v_xor_b32 v246, s21, v245
    v_xor_b32 v247, 4, v246
    v_and_b32 v245, 3, v1
    v_lshlrev_b32 v245, 3, v245
    v_lshl_add_u32 v245, v244, 8, v245
    v_lshl_add_u32 v246, v246, 5, v245
    v_lshl_add_u32 v247, v247, 5, v245
    ds_read_b64_tr_b16 v[232:233], v246
    ds_read_b64_tr_b16 v[234:235], v247 offset:1024
    s_mov_b32 s68, s46
    s_mov_b32 s69, s47
    s_mov_b32 s70, 0x2a00
    s_mov_b32 s71, 0x20000
    v_lshlrev_b32 v244, 6, v3
    s_lshl_b32 s23, s18, 2
    s_add_u32 s23, s23, 8960
    buffer_load_dwordx4 v[236:239], v244, s[68:71], s23 offen offset:0
    buffer_load_dwordx4 v[240:243], v244, s[68:71], s23 offen offset:16
k34_sig:
    s_waitcnt vmcnt(0) lgkmcnt(0)
    s_barrier
    s_lshl_b32 s15, s7, 8
    s_cmp_lg_u32 s4, 0
    s_cbranch_scc1 k34_defer
    s_mov_b64 exec, 1
    v_mov_b32 v2, 1
    buffer_atomic_add v2, off, s[72:75], s15 sc1
    s_mov_b64 exec, -1
    s_cmp_ge_u32 s17, 7
    s_cbranch_scc1 k34_wait_done
    s_mov_b32 s78, 4194304
k34_wait:
    buffer_load_dword v2, off, s[72:75], s15 sc1
    s_waitcnt vmcnt(0)
    v_readfirstlane_b32 s79, v2
    s_nop 0
    s_cmp_ge_u32 s79, 16
    s_nop 2
    s_cbranch_scc1 k34_wait_done
    s_sub_u32 s78, s78, 1
    s_cmp_eq_u32 s78, 0
    s_cbranch_scc1 k34_wait_done
    s_sleep 4
    s_branch k34_wait
k34_defer:
    buffer_load_dwordx4 v[160:163], v250, s[64:67], s22 offen offset:2048
    buffer_load_dwordx4 v[164:167], v250, s[64:67], s22 offen offset:3072
    s_add_u32 s22, s22, 4096
k34_wait_done:
    s_cmp_ge_u32 s17, 7
    s_cbranch_scc1 k34_kernel_done
    s_barrier
    s_lshl_b32 s22, s7, 3
    s_lshl_b32 s23, s16, 2
    s_add_u32 s22, s22, s23
    s_mul_i32 s22, s22, 56
    s_mul_i32 s23, s4, 7
    s_add_u32 s22, s22, s23
    s_lshl_b32 s22, s22, 10
    s_add_u32 s24, s22, 0
    s_add_u32 s28, s22, 4096
    s_add_u32 s25, s22, 57344
    s_add_u32 s29, s22, 61440
    s_add_u32 s26, s22, 114688
    s_add_u32 s30, s22, 118784
    s_add_u32 s27, s22, 172032
    s_add_u32 s31, s22, 176128
    s_lshl_b32 s22, s4, 10
    v_add_u32 v244, s22, v250
    v_add_u32 v245, 0x10000, v244
    buffer_load_dwordx4 v[8:11], v250, s[60:63], s24 offen offset:0 sc1
    buffer_load_dwordx4 v[12:15], v250, s[60:63], s25 offen offset:0 sc1
    buffer_load_dwordx4 v[16:19], v250, s[60:63], s24 offen offset:1024 sc1
    buffer_load_dwordx4 v[20:23], v250, s[60:63], s25 offen offset:1024 sc1
    buffer_load_dwordx4 v[24:27], v250, s[60:63], s24 offen offset:2048 sc1
    buffer_load_dwordx4 v[28:31], v250, s[60:63], s25 offen offset:2048 sc1
    buffer_load_dwordx4 v[32:35], v250, s[60:63], s24 offen offset:3072 sc1
    buffer_load_dwordx4 v[36:39], v250, s[60:63], s25 offen offset:3072 sc1
    buffer_load_dwordx4 v[40:43], v250, s[60:63], s28 offen offset:0 sc1
    buffer_load_dwordx4 v[44:47], v250, s[60:63], s29 offen offset:0 sc1
    buffer_load_dwordx4 v[48:51], v250, s[60:63], s28 offen offset:1024 sc1
    buffer_load_dwordx4 v[52:55], v250, s[60:63], s29 offen offset:1024 sc1
    s_waitcnt vmcnt(10)
    v_mfma_f32_16x16x32_bf16 v[168:171], v[56:59], v[8:11], 0
    v_mfma_f32_16x16x32_bf16 v[172:175], v[60:63], v[8:11], 0
    v_mfma_f32_16x16x32_bf16 v[176:179], v[64:67], v[8:11], 0
    v_mfma_f32_16x16x32_bf16 v[180:183], v[68:71], v[8:11], 0
    v_mfma_f32_16x16x32_bf16 v[184:187], v[56:59], v[12:15], 0
    v_mfma_f32_16x16x32_bf16 v[188:191], v[60:63], v[12:15], 0
    v_mfma_f32_16x16x32_bf16 v[192:195], v[64:67], v[12:15], 0
    v_mfma_f32_16x16x32_bf16 v[196:199], v[68:71], v[12:15], 0
    buffer_load_dwordx4 v[8:11], v250, s[60:63], s28 offen offset:2048 sc1
    buffer_load_dwordx4 v[12:15], v250, s[60:63], s29 offen offset:2048 sc1
    s_waitcnt vmcnt(10)
    v_mfma_f32_16x16x32_bf16 v[168:171], v[72:75], v[16:19], v[168:171]
    v_mfma_f32_16x16x32_bf16 v[172:175], v[76:79], v[16:19], v[172:175]
    v_mfma_f32_16x16x32_bf16 v[176:179], v[80:83], v[16:19], v[176:179]
    v_mfma_f32_16x16x32_bf16 v[180:183], v[84:87], v[16:19], v[180:183]
    v_mfma_f32_16x16x32_bf16 v[184:187], v[72:75], v[20:23], v[184:187]
    v_mfma_f32_16x16x32_bf16 v[188:191], v[76:79], v[20:23], v[188:191]
    v_mfma_f32_16x16x32_bf16 v[192:195], v[80:83], v[20:23], v[192:195]
    v_mfma_f32_16x16x32_bf16 v[196:199], v[84:87], v[20:23], v[196:199]
    buffer_load_dwordx4 v[16:19], v250, s[60:63], s26 offen offset:0 sc1
    buffer_load_dwordx4 v[20:23], v250, s[60:63], s27 offen offset:0 sc1
    s_waitcnt vmcnt(10)
    v_mfma_f32_16x16x32_bf16 v[168:171], v[88:91], v[24:27], v[168:171]
    v_mfma_f32_16x16x32_bf16 v[172:175], v[92:95], v[24:27], v[172:175]
    v_mfma_f32_16x16x32_bf16 v[176:179], v[96:99], v[24:27], v[176:179]
    v_mfma_f32_16x16x32_bf16 v[180:183], v[100:103], v[24:27], v[180:183]
    v_mfma_f32_16x16x32_bf16 v[184:187], v[88:91], v[28:31], v[184:187]
    v_mfma_f32_16x16x32_bf16 v[188:191], v[92:95], v[28:31], v[188:191]
    v_mfma_f32_16x16x32_bf16 v[192:195], v[96:99], v[28:31], v[192:195]
    v_mfma_f32_16x16x32_bf16 v[196:199], v[100:103], v[28:31], v[196:199]
    buffer_load_dwordx4 v[24:27], v250, s[60:63], s26 offen offset:1024 sc1
    buffer_load_dwordx4 v[28:31], v250, s[60:63], s27 offen offset:1024 sc1
    s_waitcnt vmcnt(10)
    v_mfma_f32_16x16x32_bf16 v[168:171], v[104:107], v[32:35], v[168:171]
    v_mfma_f32_16x16x32_bf16 v[172:175], v[108:111], v[32:35], v[172:175]
    v_mfma_f32_16x16x32_bf16 v[176:179], v[112:115], v[32:35], v[176:179]
    v_mfma_f32_16x16x32_bf16 v[180:183], v[116:119], v[32:35], v[180:183]
    v_mfma_f32_16x16x32_bf16 v[184:187], v[104:107], v[36:39], v[184:187]
    v_mfma_f32_16x16x32_bf16 v[188:191], v[108:111], v[36:39], v[188:191]
    v_mfma_f32_16x16x32_bf16 v[192:195], v[112:115], v[36:39], v[192:195]
    v_mfma_f32_16x16x32_bf16 v[196:199], v[116:119], v[36:39], v[196:199]
    buffer_load_dwordx4 v[32:35], v250, s[60:63], s26 offen offset:2048 sc1
    buffer_load_dwordx4 v[36:39], v250, s[60:63], s27 offen offset:2048 sc1
    s_waitcnt vmcnt(10)
    v_mfma_f32_16x16x32_bf16 v[168:171], v[120:123], v[40:43], v[168:171]
    v_mfma_f32_16x16x32_bf16 v[172:175], v[124:127], v[40:43], v[172:175]
    v_mfma_f32_16x16x32_bf16 v[176:179], v[128:131], v[40:43], v[176:179]
    v_mfma_f32_16x16x32_bf16 v[180:183], v[132:135], v[40:43], v[180:183]
    v_mfma_f32_16x16x32_bf16 v[184:187], v[120:123], v[44:47], v[184:187]
    v_mfma_f32_16x16x32_bf16 v[188:191], v[124:127], v[44:47], v[188:191]
    v_mfma_f32_16x16x32_bf16 v[192:195], v[128:131], v[44:47], v[192:195]
    v_mfma_f32_16x16x32_bf16 v[196:199], v[132:135], v[44:47], v[196:199]
    buffer_load_dwordx4 v[40:43], v250, s[60:63], s26 offen offset:3072 sc1
    buffer_load_dwordx4 v[44:47], v250, s[60:63], s27 offen offset:3072 sc1
    s_waitcnt vmcnt(10)
    v_mfma_f32_16x16x32_bf16 v[168:171], v[136:139], v[48:51], v[168:171]
    v_mfma_f32_16x16x32_bf16 v[172:175], v[140:143], v[48:51], v[172:175]
    v_mfma_f32_16x16x32_bf16 v[176:179], v[144:147], v[48:51], v[176:179]
    v_mfma_f32_16x16x32_bf16 v[180:183], v[148:151], v[48:51], v[180:183]
    v_mfma_f32_16x16x32_bf16 v[184:187], v[136:139], v[52:55], v[184:187]
    v_mfma_f32_16x16x32_bf16 v[188:191], v[140:143], v[52:55], v[188:191]
    v_mfma_f32_16x16x32_bf16 v[192:195], v[144:147], v[52:55], v[192:195]
    v_mfma_f32_16x16x32_bf16 v[196:199], v[148:151], v[52:55], v[196:199]
    buffer_load_dwordx4 v[48:51], v250, s[60:63], s30 offen offset:0 sc1
    buffer_load_dwordx4 v[52:55], v250, s[60:63], s31 offen offset:0 sc1
    s_waitcnt vmcnt(10)
    v_mfma_f32_16x16x32_bf16 v[168:171], v[152:155], v[8:11], v[168:171]
    v_mfma_f32_16x16x32_bf16 v[172:175], v[156:159], v[8:11], v[172:175]
    v_mfma_f32_16x16x32_bf16 v[176:179], v[160:163], v[8:11], v[176:179]
    v_mfma_f32_16x16x32_bf16 v[180:183], v[164:167], v[8:11], v[180:183]
    v_mfma_f32_16x16x32_bf16 v[184:187], v[152:155], v[12:15], v[184:187]
    v_mfma_f32_16x16x32_bf16 v[188:191], v[156:159], v[12:15], v[188:191]
    v_mfma_f32_16x16x32_bf16 v[192:195], v[160:163], v[12:15], v[192:195]
    v_mfma_f32_16x16x32_bf16 v[196:199], v[164:167], v[12:15], v[196:199]
    buffer_load_dwordx4 v[8:11], v250, s[60:63], s30 offen offset:1024 sc1
    buffer_load_dwordx4 v[12:15], v250, s[60:63], s31 offen offset:1024 sc1
    s_waitcnt vmcnt(10)
    v_mfma_f32_16x16x32_bf16 v[200:203], v[56:59], v[16:19], 0
    v_mfma_f32_16x16x32_bf16 v[204:207], v[60:63], v[16:19], 0
    v_mfma_f32_16x16x32_bf16 v[208:211], v[64:67], v[16:19], 0
    v_mfma_f32_16x16x32_bf16 v[212:215], v[68:71], v[16:19], 0
    v_mfma_f32_16x16x32_bf16 v[216:219], v[56:59], v[20:23], 0
    v_mfma_f32_16x16x32_bf16 v[220:223], v[60:63], v[20:23], 0
    v_mfma_f32_16x16x32_bf16 v[224:227], v[64:67], v[20:23], 0
    v_mfma_f32_16x16x32_bf16 v[228:231], v[68:71], v[20:23], 0
    buffer_load_dwordx4 v[16:19], v250, s[60:63], s30 offen offset:2048 sc1
    buffer_load_dwordx4 v[20:23], v250, s[60:63], s31 offen offset:2048 sc1
    ds_write_b128 v244, v[168:171] offset:0
    ds_write_b128 v244, v[172:175] offset:8192
    s_waitcnt vmcnt(10)
    v_mfma_f32_16x16x32_bf16 v[200:203], v[72:75], v[24:27], v[200:203]
    v_mfma_f32_16x16x32_bf16 v[204:207], v[76:79], v[24:27], v[204:207]
    v_mfma_f32_16x16x32_bf16 v[208:211], v[80:83], v[24:27], v[208:211]
    v_mfma_f32_16x16x32_bf16 v[212:215], v[84:87], v[24:27], v[212:215]
    v_mfma_f32_16x16x32_bf16 v[216:219], v[72:75], v[28:31], v[216:219]
    v_mfma_f32_16x16x32_bf16 v[220:223], v[76:79], v[28:31], v[220:223]
    v_mfma_f32_16x16x32_bf16 v[224:227], v[80:83], v[28:31], v[224:227]
    v_mfma_f32_16x16x32_bf16 v[228:231], v[84:87], v[28:31], v[228:231]
    ds_write_b128 v244, v[176:179] offset:16384
    ds_write_b128 v244, v[180:183] offset:24576
    s_waitcnt vmcnt(8)
    v_mfma_f32_16x16x32_bf16 v[200:203], v[88:91], v[32:35], v[200:203]
    v_mfma_f32_16x16x32_bf16 v[204:207], v[92:95], v[32:35], v[204:207]
    v_mfma_f32_16x16x32_bf16 v[208:211], v[96:99], v[32:35], v[208:211]
    v_mfma_f32_16x16x32_bf16 v[212:215], v[100:103], v[32:35], v[212:215]
    v_mfma_f32_16x16x32_bf16 v[216:219], v[88:91], v[36:39], v[216:219]
    v_mfma_f32_16x16x32_bf16 v[220:223], v[92:95], v[36:39], v[220:223]
    v_mfma_f32_16x16x32_bf16 v[224:227], v[96:99], v[36:39], v[224:227]
    v_mfma_f32_16x16x32_bf16 v[228:231], v[100:103], v[36:39], v[228:231]
    ds_write_b128 v244, v[184:187] offset:32768
    ds_write_b128 v244, v[188:191] offset:40960
    s_waitcnt vmcnt(6)
    v_mfma_f32_16x16x32_bf16 v[200:203], v[104:107], v[40:43], v[200:203]
    v_mfma_f32_16x16x32_bf16 v[204:207], v[108:111], v[40:43], v[204:207]
    v_mfma_f32_16x16x32_bf16 v[208:211], v[112:115], v[40:43], v[208:211]
    v_mfma_f32_16x16x32_bf16 v[212:215], v[116:119], v[40:43], v[212:215]
    v_mfma_f32_16x16x32_bf16 v[216:219], v[104:107], v[44:47], v[216:219]
    v_mfma_f32_16x16x32_bf16 v[220:223], v[108:111], v[44:47], v[220:223]
    v_mfma_f32_16x16x32_bf16 v[224:227], v[112:115], v[44:47], v[224:227]
    v_mfma_f32_16x16x32_bf16 v[228:231], v[116:119], v[44:47], v[228:231]
    ds_write_b128 v244, v[192:195] offset:49152
    ds_write_b128 v244, v[196:199] offset:57344
    s_waitcnt vmcnt(4)
    v_mfma_f32_16x16x32_bf16 v[200:203], v[120:123], v[48:51], v[200:203]
    v_mfma_f32_16x16x32_bf16 v[204:207], v[124:127], v[48:51], v[204:207]
    v_mfma_f32_16x16x32_bf16 v[208:211], v[128:131], v[48:51], v[208:211]
    v_mfma_f32_16x16x32_bf16 v[212:215], v[132:135], v[48:51], v[212:215]
    v_mfma_f32_16x16x32_bf16 v[216:219], v[120:123], v[52:55], v[216:219]
    v_mfma_f32_16x16x32_bf16 v[220:223], v[124:127], v[52:55], v[220:223]
    v_mfma_f32_16x16x32_bf16 v[224:227], v[128:131], v[52:55], v[224:227]
    v_mfma_f32_16x16x32_bf16 v[228:231], v[132:135], v[52:55], v[228:231]
    s_waitcnt vmcnt(2)
    v_mfma_f32_16x16x32_bf16 v[200:203], v[136:139], v[8:11], v[200:203]
    v_mfma_f32_16x16x32_bf16 v[204:207], v[140:143], v[8:11], v[204:207]
    v_mfma_f32_16x16x32_bf16 v[208:211], v[144:147], v[8:11], v[208:211]
    v_mfma_f32_16x16x32_bf16 v[212:215], v[148:151], v[8:11], v[212:215]
    v_mfma_f32_16x16x32_bf16 v[216:219], v[136:139], v[12:15], v[216:219]
    v_mfma_f32_16x16x32_bf16 v[220:223], v[140:143], v[12:15], v[220:223]
    v_mfma_f32_16x16x32_bf16 v[224:227], v[144:147], v[12:15], v[224:227]
    v_mfma_f32_16x16x32_bf16 v[228:231], v[148:151], v[12:15], v[228:231]
    s_waitcnt vmcnt(0)
    v_mfma_f32_16x16x32_bf16 v[200:203], v[152:155], v[16:19], v[200:203]
    v_mfma_f32_16x16x32_bf16 v[204:207], v[156:159], v[16:19], v[204:207]
    v_mfma_f32_16x16x32_bf16 v[208:211], v[160:163], v[16:19], v[208:211]
    v_mfma_f32_16x16x32_bf16 v[212:215], v[164:167], v[16:19], v[212:215]
    v_mfma_f32_16x16x32_bf16 v[216:219], v[152:155], v[20:23], v[216:219]
    v_mfma_f32_16x16x32_bf16 v[220:223], v[156:159], v[20:23], v[220:223]
    v_mfma_f32_16x16x32_bf16 v[224:227], v[160:163], v[20:23], v[224:227]
    v_mfma_f32_16x16x32_bf16 v[228:231], v[164:167], v[20:23], v[228:231]
    s_nop 0
    ds_write_b128 v245, v[200:203] offset:0
    ds_write_b128 v245, v[204:207] offset:8192
    ds_write_b128 v245, v[208:211] offset:16384
    ds_write_b128 v245, v[212:215] offset:24576
    ds_write_b128 v245, v[216:219] offset:32768
    ds_write_b128 v245, v[220:223] offset:40960
    ds_write_b128 v245, v[224:227] offset:49152
    ds_write_b128 v245, v[228:231] offset:57344
    s_waitcnt lgkmcnt(0)
    s_barrier
    s_lshl_b32 s22, s4, 14
    v_add_u32 v244, s22, v250
    ds_read_b128 v[56:59], v244 offset:0
    ds_read_b128 v[60:63], v244 offset:1024
    ds_read_b128 v[64:67], v244 offset:2048
    ds_read_b128 v[68:71], v244 offset:3072
    ds_read_b128 v[72:75], v244 offset:4096
    ds_read_b128 v[76:79], v244 offset:5120
    ds_read_b128 v[80:83], v244 offset:6144
    ds_read_b128 v[84:87], v244 offset:7168
    ds_read_b128 v[88:91], v244 offset:8192
    ds_read_b128 v[92:95], v244 offset:9216
    ds_read_b128 v[96:99], v244 offset:10240
    ds_read_b128 v[100:103], v244 offset:11264
    ds_read_b128 v[104:107], v244 offset:12288
    ds_read_b128 v[108:111], v244 offset:13312
    ds_read_b128 v[112:115], v244 offset:14336
    ds_read_b128 v[116:119], v244 offset:15360
    s_mov_b32 s48, s42
    s_mov_b32 s49, s43
    s_mov_b32 s50, 0x1c0000
    s_mov_b32 s51, 0x20000
    v_mul_u32_u24 v246, 896, v4
    v_lshl_add_u32 v246, v3, 5, v246
    s_lshl_b32 s22, s7, 3
    s_add_u32 s22, s22, s21
    s_mul_i32 s22, s22, 14336
    s_lshl_b32 s23, s18, 1
    s_add_u32 s22, s22, s23
    v_lshlrev_b32 v8, 16, v232
    v_and_b32 v9, 0xffff0000, v232
    v_lshlrev_b32 v10, 16, v233
    v_and_b32 v11, 0xffff0000, v233
    v_lshlrev_b32 v12, 16, v234
    v_and_b32 v13, 0xffff0000, v234
    v_lshlrev_b32 v14, 16, v235
    v_and_b32 v15, 0xffff0000, v235
    s_waitcnt lgkmcnt(8)
    v_pk_add_f32 v[56:57], v[56:57], v[72:73]
    v_pk_add_f32 v[58:59], v[58:59], v[74:75]
    v_pk_add_f32 v[60:61], v[60:61], v[76:77]
    v_pk_add_f32 v[62:63], v[62:63], v[78:79]
    v_pk_add_f32 v[64:65], v[64:65], v[80:81]
    v_pk_add_f32 v[66:67], v[66:67], v[82:83]
    v_pk_add_f32 v[68:69], v[68:69], v[84:85]
    v_pk_add_f32 v[70:71], v[70:71], v[86:87]
    v_pk_add_f32 v[56:57], v[56:57], v[64:65]
    v_pk_add_f32 v[58:59], v[58:59], v[66:67]
    v_pk_add_f32 v[60:61], v[60:61], v[68:69]
    v_pk_add_f32 v[62:63], v[62:63], v[70:71]
    v_pk_add_f32 v[56:57], v[56:57], v[60:61]
    v_pk_add_f32 v[58:59], v[58:59], v[62:63]
    s_waitcnt lgkmcnt(0)
    v_pk_add_f32 v[88:89], v[88:89], v[104:105]
    v_pk_add_f32 v[90:91], v[90:91], v[106:107]
    v_pk_add_f32 v[92:93], v[92:93], v[108:109]
    v_pk_add_f32 v[94:95], v[94:95], v[110:111]
    v_pk_add_f32 v[96:97], v[96:97], v[112:113]
    v_pk_add_f32 v[98:99], v[98:99], v[114:115]
    v_pk_add_f32 v[100:101], v[100:101], v[116:117]
    v_pk_add_f32 v[102:103], v[102:103], v[118:119]
    v_pk_add_f32 v[88:89], v[88:89], v[96:97]
    v_pk_add_f32 v[90:91], v[90:91], v[98:99]
    v_pk_add_f32 v[92:93], v[92:93], v[100:101]
    v_pk_add_f32 v[94:95], v[94:95], v[102:103]
    v_pk_add_f32 v[88:89], v[88:89], v[92:93]
    v_pk_add_f32 v[90:91], v[90:91], v[94:95]
    v_cvt_pk_bf16_f32 v24, v56, v57
    v_cvt_pk_bf16_f32 v25, v58, v59
    v_cvt_pk_bf16_f32 v26, v88, v89
    v_cvt_pk_bf16_f32 v27, v90, v91
    v_lshlrev_b32 v16, 16, v24
    v_and_b32 v17, 0xffff0000, v24
    v_lshlrev_b32 v18, 16, v25
    v_and_b32 v19, 0xffff0000, v25
    v_lshlrev_b32 v20, 16, v26
    v_and_b32 v21, 0xffff0000, v26
    v_lshlrev_b32 v22, 16, v27
    v_and_b32 v23, 0xffff0000, v27
    v_pk_mul_f32 v[16:17], v[16:17], v[236:237]
    v_pk_mul_f32 v[18:19], v[18:19], v[238:239]
    v_pk_mul_f32 v[20:21], v[20:21], v[240:241]
    v_pk_mul_f32 v[22:23], v[22:23], v[242:243]
    v_cvt_pk_bf16_f32 v24, v16, v17
    v_cvt_pk_bf16_f32 v25, v18, v19
    v_cvt_pk_bf16_f32 v26, v20, v21
    v_cvt_pk_bf16_f32 v27, v22, v23
    v_lshlrev_b32 v16, 16, v24
    v_and_b32 v17, 0xffff0000, v24
    v_lshlrev_b32 v18, 16, v25
    v_and_b32 v19, 0xffff0000, v25
    v_lshlrev_b32 v20, 16, v26
    v_and_b32 v21, 0xffff0000, v26
    v_lshlrev_b32 v22, 16, v27
    v_and_b32 v23, 0xffff0000, v27
    v_pk_add_f32 v[16:17], v[16:17], v[8:9]
    v_pk_add_f32 v[18:19], v[18:19], v[10:11]
    v_pk_add_f32 v[20:21], v[20:21], v[12:13]
    v_pk_add_f32 v[22:23], v[22:23], v[14:15]
    v_cvt_pk_bf16_f32 v24, v16, v17
    v_cvt_pk_bf16_f32 v25, v18, v19
    v_cvt_pk_bf16_f32 v26, v20, v21
    v_cvt_pk_bf16_f32 v27, v22, v23
    buffer_store_dwordx4 v[24:27], v246, s[48:51], s22 offen
    s_nop 1
k34_kernel_done:
    s_endpgm
k34_kernel_exit:
    s_endpgm
.section .rodata,"a"
.p2align 6
.amdhsa_kernel k12_kernel
  .amdhsa_next_free_vgpr 164
  .amdhsa_next_free_sgpr 96
  .amdhsa_accum_offset 164
  .amdhsa_group_segment_fixed_size 0
  .amdhsa_kernarg_size 128
  .amdhsa_user_sgpr_count 2
  .amdhsa_user_sgpr_kernarg_segment_ptr 1
  .amdhsa_system_sgpr_workgroup_id_x 1
.end_amdhsa_kernel
.p2align 6
.amdhsa_kernel k34_kernel
  .amdhsa_next_free_vgpr 256
  .amdhsa_next_free_sgpr 96
  .amdhsa_accum_offset 256
  .amdhsa_group_segment_fixed_size 0
  .amdhsa_kernarg_size 128
  .amdhsa_user_sgpr_count 2
  .amdhsa_user_sgpr_kernarg_segment_ptr 1
  .amdhsa_system_sgpr_workgroup_id_x 1
.end_amdhsa_kernel
```
